```python
import torch

def _softmax(x, axis=-1):
    return torch.softmax(x, dim=axis)

def _gelu(x):
    return torch.nn.functional.gelu(x, approximate='tanh')

def _silu(x):
    return torch.nn.functional.silu(x)

def _sigmoid(x):
    return torch.sigmoid(x)

def _layernorm(x, axis=-1, eps=1e-05):
    m = x.mean(dim=axis, keepdim=True)
    v = x.var(dim=axis, keepdim=True, unbiased=False)
    return (x - m) / torch.sqrt(v + eps)

def _scatter_add(tgt, idx, src, axis=0):
    return tgt.clone().index_add_(axis, idx, src)

def _segment_sum(src, seg, n):
    out = torch.zeros((n,) + src.shape[1:], dtype=src.dtype)
    return out.index_add_(0, seg, src)

def _pad(x, pw):
    flat = tuple((v for pair in reversed(pw) for v in pair))
    return torch.nn.functional.pad(x, flat)
kernel_name = 'adaLN_cond__mha_block_cached__glu_gated_bilinear__decode'

def setup_inputs():

    _w = lambda a: (lambda t: t.to(torch.bfloat16) if t.is_floating_point() else t)(torch.as_tensor(a))

    def _A_setup():
        B, Sq, D = (2, 1, 512)
        H, Sk, Dh = (32, 32768, 128)
        return {'x': _w((lambda *s: torch.randn(*s, dtype=torch.bfloat16) * 0.05)(B, Sq, D)), 'k_cache': _w((lambda *s: torch.randn(*s, dtype=torch.bfloat16) * 0.8)(B, H, Sk, Dh)), 'v_cache': _w((lambda *s: torch.randn(*s, dtype=torch.bfloat16) * 3.2)(B, H, Sk, Dh)), 'wq': _w((lambda *s: torch.randn(*s, dtype=torch.bfloat16) * 0.8)(D, H * Dh) * D ** (-0.5)), 'wo': _w((lambda *s: torch.randn(*s, dtype=torch.bfloat16) * 3.2)(H * Dh, D) * (H * Dh) ** (-0.5))}
    _A_in = _A_setup()

    def _B_setup():
        B, S, D, F = (2, 1, 512, 1792)
        return {'x': _w((lambda *s: torch.randn(*s, dtype=torch.bfloat16) * 0.05)(B, S, D)), 'w_gate': _w((lambda *s: torch.randn(*s, dtype=torch.bfloat16) * 3.2)(D, F) * D ** (-0.5)), 'w_up': _w((lambda *s: torch.randn(*s, dtype=torch.bfloat16) * 3.2)(D, F) * D ** (-0.5)), 'w_down': _w((lambda *s: torch.randn(*s, dtype=torch.bfloat16) * 3.2)(F, D) * F ** (-0.5))}
    _B_in = _B_setup()
    return {'A_x': _A_in['x'], 'A_k_cache': _A_in['k_cache'], 'A_v_cache': _A_in['v_cache'], 'A_wq': _A_in['wq'], 'A_wo': _A_in['wo'], 'B_x': _B_in['x'], 'B_w_gate': _B_in['w_gate'], 'B_w_up': _B_in['w_up'], 'B_w_down': _B_in['w_down'], 'c': _w((lambda *s: torch.randn(*s, dtype=torch.bfloat16) * 0.2)(2, 512) * 8.0), 'w_mod': _w((lambda *s: torch.randn(*s, dtype=torch.bfloat16) * 0.2)(512, 6 * 512) * 512 ** (-0.5) * 8.0)}

def reference(A_x, A_k_cache, A_v_cache, A_wq, A_wo, B_x, B_w_gate, B_w_up, B_w_down, c, w_mod):

    def _A_ref(x, k_cache, v_cache, wq, wo):
        B, Sq, D = x.shape
        H, Dh = (32, 128)
        q = (lambda x, *d: x.permute(*d))((x @ wq).reshape(B, Sq, H, Dh), 0, 2, 1, 3)
        scores = torch.einsum('bhqd,bhkd->bhqk', q, k_cache) * Dh ** (-0.5)
        p = _softmax(scores, axis=-1)
        o = torch.einsum('bhqk,bhkd->bhqd', p, v_cache)
        return (lambda x, *d: x.permute(*d))(o, 0, 2, 1, 3).reshape(B, Sq, H * Dh) @ wo

    def _B_ref(x, w_gate, w_up, w_down):
        g = torch.einsum('bsd,df->bsf', x, w_gate)
        u = torch.einsum('bsd,df->bsf', x, w_up)
        h = g * u
        return torch.einsum('bsf,fd->bsd', h, w_down)
    x = A_x
    mod = (_silu(c) @ w_mod).reshape(c.shape[0], 6, 1, -1)
    sa, ca, ga, sb, cb, gb = (mod[:, 0].clone(), mod[:, 1].clone(), mod[:, 2].clone(), mod[:, 3].clone(), mod[:, 4].clone(), mod[:, 5].clone())
    h = _layernorm(x, axis=-1) * (1 + ca) + sa
    x = x + ga * _A_ref(h, A_k_cache, A_v_cache, A_wq, A_wo)
    h = _layernorm(x, axis=-1) * (1 + cb) + sb
    x = x + gb * _B_ref(h, B_w_gate, B_w_up, B_w_down)
    return x
```

```asm
; @launch grid=(256,1,1) block=(512,1,1) lds=163840
.amdgcn_target "amdgcn-amd-amdhsa--gfx950"
.text
.globl adaLN_cond__mha_block_cached__glu_gated_bilinear__decode_kernel
.p2align 8
.type adaLN_cond__mha_block_cached__glu_gated_bilinear__decode_kernel,@function
adaLN_cond__mha_block_cached__glu_gated_bilinear__decode_kernel:
    s_cmp_ge_u32 s2, 256
    s_cbranch_scc1 L_end
    s_load_dwordx16 s[8:23], s[0:1], 0
    s_load_dwordx8 s[24:31], s[0:1], 64
    s_load_dwordx4 s[32:35], s[0:1], 96
    v_lshrrev_b32 v1, 6, v0
    v_and_b32 v0, 63, v0
    v_readfirstlane_b32 s3, v1
    s_mov_b32 s53, 0x3fb8aa3b
    s_mov_b32 s54, 0x3db504f3
    s_mov_b32 s55, 0xffff0000
    s_bfe_u32 s4, s2, 0x10001
    s_lshr_b32 s64, s2, 3
    s_lshl_b32 s64, s64, 1
    s_add_u32 s64, s64, s4
    s_bfe_u32 s93, s2, 0x10002
    s_lshl_b32 s93, s93, 1
    s_and_b32 s4, s2, 1
    s_add_u32 s93, s93, s4
    s_and_b32 s4, s64, 2
    s_xor_b32 s4, s4, s93
    s_lshl_b32 s4, s4, 6
    s_add_u32 s96, s4, s64
    s_mov_b32 s68, 0
    s_lshr_b32 s65, s2, 7
    s_and_b32 s66, s64, 31
    s_and_b32 s70, s3, 3
    s_mov_b32 s69, 0
    s_cmp_ge_u32 s3, 4
    s_cbranch_scc1 L_helper
    v_bfe_u32 v1, v0, 2, 1
    v_lshlrev_b32 v1, 8, v1
    v_bfe_u32 v2, v0, 3, 1
    v_lshl_add_u32 v1, v2, 15, v1
    v_lshrrev_b32 v2, 4, v0
    v_lshl_add_u32 v1, v2, 6, v1
    v_and_b32 v2, 3, v0
    v_lshl_add_u32 v36, v2, 4, v1
    v_add_u32 v37, 4096, v36
    v_add_u32 v38, 16384, v36
    v_add_u32 v39, 20480, v36
    s_lshl_b32 s5, s93, 1
    s_lshr_b32 s91, s70, 1
    s_add_u32 s91, s5, s91
    s_and_b32 s46, s70, 1
    s_mov_b32 s48, s46
    s_lshl_b32 s5, s46, 8
    s_add_u32 s91, s91, s5
    s_add_u32 s47, s91, 32
    s_lshl_b32 s6, s64, 23
    s_lshl_b32 s7, s64, 8
    s_add_u32 s7, s7, 32768
    s_waitcnt lgkmcnt(0)
    s_add_u32 s40, s10, s6
    s_addc_u32 s41, s11, 0
    s_add_u32 s42, s12, s6
    s_addc_u32 s43, s13, 0
    s_add_u32 s44, s34, s7
    s_addc_u32 s45, s35, 0
    s_mov_b32 s97, 0
    s_add_u32 s98, s34, 0
    s_addc_u32 s99, s35, 0
    s_lshl_b32 s15, s46, 8
    s_lshl_b32 s16, s46, 2
    s_mov_b32 s14, 0
    s_mov_b32 s17, 0
    s_mov_b32 s10, 0
    s_mov_b32 s11, 0
    s_mov_b32 s12, s48
    s_mov_b32 s26, 0
    s_add_u32 s91, s47, 8
    s_xor_b32 s6, s47, s68
    s_bfe_u32 s4, s6, 0x10000
    s_lshl_b32 s4, s4, 9
    s_bfe_u32 s5, s6, 0x20001
    s_lshl_b32 s5, s5, 16
    s_or_b32 s4, s4, s5
    s_bfe_u32 s5, s6, 0x20003
    s_lshl_b32 s5, s5, 21
    s_or_b32 s4, s4, s5
    s_bfe_u32 s5, s6, 0x10005
    s_lshl_b32 s5, s5, 20
    s_or_b32 s4, s4, s5
    s_bfe_u32 s5, s6, 0x10006
    s_lshl_b32 s5, s5, 19
    s_or_b32 s4, s4, s5
    s_bfe_u32 s5, s6, 0x10007
    s_lshl_b32 s5, s5, 18
    s_or_b32 s4, s4, s5
    s_bfe_u32 s5, s6, 0x10008
    s_lshl_b32 s5, s5, 13
    s_or_b32 s4, s4, s5
    s_lshr_b32 s5, s4, 8
    s_and_b32 s5, s5, 8192
    s_xor_b32 s4, s4, s5
    s_add_u32 s36, s40, s4
    s_addc_u32 s37, s41, 0
    s_xor_b32 s6, s91, s68
    s_bfe_u32 s4, s6, 0x10000
    s_lshl_b32 s4, s4, 9
    s_bfe_u32 s5, s6, 0x20001
    s_lshl_b32 s5, s5, 16
    s_or_b32 s4, s4, s5
    s_bfe_u32 s5, s6, 0x20003
    s_lshl_b32 s5, s5, 21
    s_or_b32 s4, s4, s5
    s_bfe_u32 s5, s6, 0x10005
    s_lshl_b32 s5, s5, 20
    s_or_b32 s4, s4, s5
    s_bfe_u32 s5, s6, 0x10006
    s_lshl_b32 s5, s5, 19
    s_or_b32 s4, s4, s5
    s_bfe_u32 s5, s6, 0x10007
    s_lshl_b32 s5, s5, 18
    s_or_b32 s4, s4, s5
    s_bfe_u32 s5, s6, 0x10008
    s_lshl_b32 s5, s5, 13
    s_or_b32 s4, s4, s5
    s_lshr_b32 s5, s4, 8
    s_and_b32 s5, s5, 8192
    s_xor_b32 s4, s4, s5
    s_add_u32 s38, s40, s4
    s_addc_u32 s39, s41, 0
    s_cmp_ge_u32 s96, 17
    s_cbranch_scc1 L_nohold
    s_barrier
    v_mov_b32 v1, 11072
L_lw_1:
    ds_read_b32 v2, v1
    s_waitcnt lgkmcnt(0)
    v_cmp_gt_u32 vcc, 4, v2
    s_cbranch_vccnz L_lw_1
    global_load_dwordx4 v[128:131], v36, s[36:37] offset:0 nt
    global_load_dwordx4 v[132:135], v37, s[36:37] offset:0 nt
    global_load_dwordx4 v[136:139], v38, s[36:37] offset:0 nt
    global_load_dwordx4 v[140:143], v39, s[36:37] offset:0 nt
    global_load_dwordx4 v[144:147], v36, s[36:37] offset:1024 nt
    global_load_dwordx4 v[148:151], v37, s[36:37] offset:1024 nt
    s_branch L_hold
L_nohold:
    global_load_dwordx4 v[128:131], v36, s[36:37] offset:0 nt
    global_load_dwordx4 v[132:135], v37, s[36:37] offset:0 nt
    global_load_dwordx4 v[136:139], v38, s[36:37] offset:0 nt
    global_load_dwordx4 v[140:143], v39, s[36:37] offset:0 nt
    global_load_dwordx4 v[144:147], v36, s[36:37] offset:1024 nt
    global_load_dwordx4 v[148:151], v37, s[36:37] offset:1024 nt
    s_barrier
L_hold:
    v_bfe_u32 v2, v0, 2, 2
    v_cmp_eq_u32 s[56:57], 0, v2
    v_cmp_eq_u32 s[58:59], 1, v2
    v_cmp_eq_u32 s[60:61], 2, v2
    v_cmp_eq_u32 s[62:63], 3, v2
    v_and_b32 v1, 1, v0
    v_mov_b32 v3, 0xffff
    v_lshlrev_b32 v1, 4, v1
    v_lshlrev_b32 v3, v1, v3
    v_bfe_u32 v2, v0, 1, 3
    v_cmp_eq_u32 vcc, 0, v2
    s_nop 1
    v_cndmask_b32 v8, 0, v3, vcc
    v_cmp_eq_u32 vcc, 1, v2
    s_nop 1
    v_cndmask_b32 v9, 0, v3, vcc
    v_cmp_eq_u32 vcc, 2, v2
    s_nop 1
    v_cndmask_b32 v10, 0, v3, vcc
    v_cmp_eq_u32 vcc, 3, v2
    s_nop 1
    v_cndmask_b32 v11, 0, v3, vcc
    v_mov_b32 v12, 0xff800000
    v_mov_b32 v13, 0
    v_lshl_add_u32 v14, v0, 3, s47
    s_mov_b32 s92, 0
    v_mov_b32 v16, 0
    v_mov_b32 v17, 0
    v_mov_b32 v18, 0
    v_mov_b32 v19, 0
    v_lshrrev_b32 v1, 2, v0
    v_lshlrev_b32 v46, 3, v1
    s_mul_i32 s4, s70, 12288
    s_add_u32 s4, s4, 114688
    v_add_u32 v15, s4, v46
    s_mul_i32 s4, s64, 8192
    s_add_u32 s4, s4, 598016
    s_add_u32 s94, s34, s4
    s_addc_u32 s95, s35, 0
    v_lshrrev_b32 v1, 4, v0
    v_and_b32 v2, 3, v0
    v_lshl_add_u32 v1, v1, 2, v2
    v_lshlrev_b32 v47, 4, v1
    s_waitcnt vmcnt(5)
    global_load_dwordx4 v[152:155], v38, s[36:37] offset:1024 nt
    s_waitcnt vmcnt(5)
    global_load_dwordx4 v[156:159], v39, s[36:37] offset:1024 nt
    s_waitcnt vmcnt(5)
    global_load_dwordx4 v[160:163], v36, s[36:37] offset:2048 nt
    s_waitcnt vmcnt(5)
    global_load_dwordx4 v[164:167], v37, s[36:37] offset:2048 nt
    s_waitcnt vmcnt(5)
    global_load_dwordx4 v[168:171], v38, s[36:37] offset:2048 nt
    s_waitcnt vmcnt(5)
    global_load_dwordx4 v[172:175], v39, s[36:37] offset:2048 nt
    s_waitcnt vmcnt(5)
    global_load_dwordx4 v[176:179], v36, s[36:37] offset:3072 nt
    s_waitcnt vmcnt(5)
    global_load_dwordx4 v[180:183], v37, s[36:37] offset:3072 nt
    s_waitcnt vmcnt(5)
    global_load_dwordx4 v[184:187], v38, s[36:37] offset:3072 nt
    s_waitcnt vmcnt(5)
    global_load_dwordx4 v[188:191], v39, s[36:37] offset:3072 nt
    s_waitcnt vmcnt(5)
    global_load_dwordx4 v[192:195], v36, s[38:39] offset:0 nt
    s_waitcnt vmcnt(5)
    global_load_dwordx4 v[196:199], v37, s[38:39] offset:0 nt
    s_waitcnt vmcnt(5)
    global_load_dwordx4 v[200:203], v38, s[38:39] offset:0 nt
    s_waitcnt vmcnt(5)
    global_load_dwordx4 v[204:207], v39, s[38:39] offset:0 nt
    s_waitcnt vmcnt(5)
    global_load_dwordx4 v[208:211], v36, s[38:39] offset:1024 nt
    s_waitcnt vmcnt(5)
    global_load_dwordx4 v[212:215], v37, s[38:39] offset:1024 nt
    s_waitcnt vmcnt(5)
    global_load_dwordx4 v[216:219], v38, s[38:39] offset:1024 nt
    s_waitcnt vmcnt(5)
    global_load_dwordx4 v[220:223], v39, s[38:39] offset:1024 nt
    s_waitcnt vmcnt(5)
    global_load_dwordx4 v[224:227], v36, s[38:39] offset:2048 nt
    s_waitcnt vmcnt(5)
    global_load_dwordx4 v[228:231], v37, s[38:39] offset:2048 nt
    s_waitcnt vmcnt(5)
    global_load_dwordx4 v[232:235], v38, s[38:39] offset:2048 nt
    s_waitcnt vmcnt(5)
    global_load_dwordx4 v[236:239], v39, s[38:39] offset:2048 nt
    s_waitcnt vmcnt(5)
    global_load_dwordx4 v[240:243], v36, s[38:39] offset:3072 nt
    s_waitcnt vmcnt(5)
    global_load_dwordx4 v[244:247], v37, s[38:39] offset:3072 nt
    s_waitcnt vmcnt(5)
    global_load_dwordx4 v[248:251], v38, s[38:39] offset:3072 nt
    s_waitcnt vmcnt(5)
    global_load_dwordx4 v[252:255], v39, s[38:39] offset:3072 nt
    s_add_u32 s47, s91, 8
    s_xor_b32 s6, s47, s68
    s_bfe_u32 s4, s6, 0x10000
    s_lshl_b32 s4, s4, 9
    s_bfe_u32 s5, s6, 0x20001
    s_lshl_b32 s5, s5, 16
    s_or_b32 s4, s4, s5
    s_bfe_u32 s5, s6, 0x20003
    s_lshl_b32 s5, s5, 21
    s_or_b32 s4, s4, s5
    s_bfe_u32 s5, s6, 0x10005
    s_lshl_b32 s5, s5, 20
    s_or_b32 s4, s4, s5
    s_bfe_u32 s5, s6, 0x10006
    s_lshl_b32 s5, s5, 19
    s_or_b32 s4, s4, s5
    s_bfe_u32 s5, s6, 0x10007
    s_lshl_b32 s5, s5, 18
    s_or_b32 s4, s4, s5
    s_bfe_u32 s5, s6, 0x10008
    s_lshl_b32 s5, s5, 13
    s_or_b32 s4, s4, s5
    s_lshr_b32 s5, s4, 8
    s_and_b32 s5, s5, 8192
    s_xor_b32 s4, s4, s5
    s_add_u32 s36, s40, s4
    s_addc_u32 s37, s41, 0
    s_waitcnt vmcnt(5)
    global_load_dwordx4 v[88:91], v36, s[36:37] offset:0 nt
    s_waitcnt vmcnt(5)
    global_load_dwordx4 v[92:95], v37, s[36:37] offset:0 nt
    s_waitcnt vmcnt(5)
    global_load_dwordx4 v[96:99], v38, s[36:37] offset:0 nt
    s_waitcnt vmcnt(5)
    global_load_dwordx4 v[100:103], v39, s[36:37] offset:0 nt
    s_waitcnt vmcnt(5)
    global_load_dwordx4 v[104:107], v36, s[36:37] offset:1024 nt
    s_waitcnt vmcnt(5)
    global_load_dwordx4 v[108:111], v37, s[36:37] offset:1024 nt
    s_waitcnt vmcnt(5)
    global_load_dwordx4 v[112:115], v38, s[36:37] offset:1024 nt
    s_waitcnt vmcnt(5)
    global_load_dwordx4 v[116:119], v39, s[36:37] offset:1024 nt
    s_waitcnt vmcnt(5)
    global_load_dwordx4 v[120:123], v36, s[36:37] offset:2048 nt
    s_waitcnt vmcnt(5)
    global_load_dwordx4 v[124:127], v37, s[36:37] offset:2048 nt
    s_mul_i32 s7, s70, 12288
    s_add_u32 s7, s7, 114688
    v_lshl_add_u32 v51, v0, 4, s7
    s_waitcnt vmcnt(5)
    s_add_u32 m0, s7, 4096
    s_nop 0
    global_load_lds_dwordx4 v38, s[36:37] offset:2048 nt
    s_waitcnt vmcnt(5)
    s_add_u32 m0, s7, 5120
    s_nop 0
    global_load_lds_dwordx4 v39, s[36:37] offset:2048 nt
    s_waitcnt vmcnt(5)
    s_add_u32 m0, s7, 5120
    s_nop 0
    global_load_lds_dwordx4 v36, s[36:37] offset:3072 nt
    s_waitcnt vmcnt(5)
    s_add_u32 m0, s7, 6144
    s_nop 0
    global_load_lds_dwordx4 v37, s[36:37] offset:3072 nt
    s_waitcnt vmcnt(5)
    s_add_u32 m0, s7, 7168
    s_nop 0
    global_load_lds_dwordx4 v38, s[36:37] offset:3072 nt
    s_waitcnt vmcnt(5)
    s_add_u32 m0, s7, 8192
    s_nop 0
    global_load_lds_dwordx4 v39, s[36:37] offset:3072 nt
    s_add_u32 s47, s91, 16
    s_xor_b32 s6, s47, s68
    s_bfe_u32 s4, s6, 0x10000
    s_lshl_b32 s4, s4, 9
    s_bfe_u32 s5, s6, 0x20001
    s_lshl_b32 s5, s5, 16
    s_or_b32 s4, s4, s5
    s_bfe_u32 s5, s6, 0x20003
    s_lshl_b32 s5, s5, 21
    s_or_b32 s4, s4, s5
    s_bfe_u32 s5, s6, 0x10005
    s_lshl_b32 s5, s5, 20
    s_or_b32 s4, s4, s5
    s_bfe_u32 s5, s6, 0x10006
    s_lshl_b32 s5, s5, 19
    s_or_b32 s4, s4, s5
    s_bfe_u32 s5, s6, 0x10007
    s_lshl_b32 s5, s5, 18
    s_or_b32 s4, s4, s5
    s_bfe_u32 s5, s6, 0x10008
    s_lshl_b32 s5, s5, 13
    s_or_b32 s4, s4, s5
    s_lshr_b32 s5, s4, 8
    s_and_b32 s5, s5, 8192
    s_xor_b32 s4, s4, s5
    s_add_u32 s36, s40, s4
    s_addc_u32 s37, s41, 0
    s_waitcnt vmcnt(5)
    s_add_u32 m0, s7, 0
    s_nop 0
    global_load_lds_dwordx4 v36, s[36:37] offset:0 nt
    s_waitcnt vmcnt(5)
    s_add_u32 m0, s7, 1024
    s_nop 0
    global_load_lds_dwordx4 v37, s[36:37] offset:0 nt
    s_waitcnt vmcnt(5)
    s_add_u32 m0, s7, 2048
    s_nop 0
    global_load_lds_dwordx4 v38, s[36:37] offset:0 nt
    s_waitcnt vmcnt(5)
    s_add_u32 m0, s7, 3072
    s_nop 0
    global_load_lds_dwordx4 v39, s[36:37] offset:0 nt
    s_waitcnt vmcnt(5)
    s_add_u32 m0, s7, 3072
    s_nop 0
    global_load_lds_dwordx4 v36, s[36:37] offset:1024 nt
    s_waitcnt vmcnt(5)
    s_add_u32 m0, s7, 4096
    s_nop 0
    global_load_lds_dwordx4 v37, s[36:37] offset:1024 nt
    v_mov_b32 v1, 11080
L_lw_2:
    ds_read_b32 v2, v1
    s_waitcnt lgkmcnt(0)
    v_cmp_gt_u32 vcc, 1, v2
    s_cbranch_vccnz L_lw_2
    ds_read_b128 v[64:67], v47 offset:2304
    s_waitcnt lgkmcnt(0)
    v_cndmask_b32 v20, 0, v64, s[56:57]
    v_cndmask_b32 v21, 0, v65, s[56:57]
    v_cndmask_b32 v22, 0, v66, s[56:57]
    v_cndmask_b32 v23, 0, v67, s[56:57]
    v_cndmask_b32 v24, 0, v64, s[58:59]
    v_cndmask_b32 v25, 0, v65, s[58:59]
    v_cndmask_b32 v26, 0, v66, s[58:59]
    v_cndmask_b32 v27, 0, v67, s[58:59]
    v_cndmask_b32 v28, 0, v64, s[60:61]
    v_cndmask_b32 v29, 0, v65, s[60:61]
    v_cndmask_b32 v30, 0, v66, s[60:61]
    v_cndmask_b32 v31, 0, v67, s[60:61]
    v_cndmask_b32 v32, 0, v64, s[62:63]
    v_cndmask_b32 v33, 0, v65, s[62:63]
    v_cndmask_b32 v34, 0, v66, s[62:63]
    v_cndmask_b32 v35, 0, v67, s[62:63]
    s_mov_b32 s90, 0
    s_cmp_lg_u32 s14, 0
    s_cbranch_scc1 L_kfullp
L_dc0kp:
    s_cmp_lg_u32 s10, 0
    s_cbranch_scc1 L_deckp
    v_mov_b32 v1, 11088
    ds_read_b64 v[2:3], v1
    s_waitcnt lgkmcnt(0)
    v_readfirstlane_b32 s4, v2
    v_readfirstlane_b32 s5, v3
    s_nop 0
    s_and_b32 s6, s4, s5
    s_bitcmp0_b32 s6, 1
    s_cbranch_scc1 L_deckp
    s_mov_b32 s10, 1
    s_or_b32 s6, s4, s5
    s_cmp_gt_u32 s6, 3
    s_cbranch_scc1 L_deckp
    s_xor_b32 s11, s4, s5
    s_and_b32 s48, s4, 1
    s_and_b32 s12, s5, 1
    s_cmp_lg_u32 s17, 0
    s_cbranch_scc1 L_deckp
    s_lshl_b32 s15, s48, 8
    s_lshl_b32 s16, s48, 2
L_deckp:
    s_mov_b32 s46, 512
    s_cmp_ge_u32 s90, 44
    s_cbranch_scc1 L_kfullp
    s_mov_b32 s46, 1
    s_atomic_add s46, s[44:45], s16 glc
L_kfullp:
    s_waitcnt vmcnt(53)
    v_mfma_f32_16x16x32_bf16 v[72:75], v[128:131], v[20:23], 0
    s_waitcnt vmcnt(52)
    v_mfma_f32_16x16x32_bf16 v[72:75], v[132:135], v[24:27], v[72:75]
    s_waitcnt vmcnt(51)
    v_mfma_f32_16x16x32_bf16 v[72:75], v[136:139], v[28:31], v[72:75]
    s_waitcnt vmcnt(50)
    v_mfma_f32_16x16x32_bf16 v[72:75], v[140:143], v[32:35], v[72:75]
    s_waitcnt vmcnt(49)
    v_mfma_f32_16x16x32_bf16 v[76:79], v[144:147], v[20:23], 0
    s_waitcnt vmcnt(48)
    v_mfma_f32_16x16x32_bf16 v[76:79], v[148:151], v[24:27], v[76:79]
    s_waitcnt vmcnt(47)
    v_mfma_f32_16x16x32_bf16 v[76:79], v[152:155], v[28:31], v[76:79]
    global_load_dwordx4 v[152:155], v38, s[36:37] offset:1024 nt
    s_waitcnt vmcnt(47)
    v_mfma_f32_16x16x32_bf16 v[76:79], v[156:159], v[32:35], v[76:79]
    global_load_dwordx4 v[156:159], v39, s[36:37] offset:1024 nt
    s_waitcnt vmcnt(47)
    v_mfma_f32_16x16x32_bf16 v[80:83], v[160:163], v[20:23], 0
    global_load_dwordx4 v[160:163], v36, s[36:37] offset:2048 nt
    s_waitcnt vmcnt(47)
    v_mfma_f32_16x16x32_bf16 v[80:83], v[164:167], v[24:27], v[80:83]
    global_load_dwordx4 v[164:167], v37, s[36:37] offset:2048 nt
    s_waitcnt vmcnt(47)
    v_mfma_f32_16x16x32_bf16 v[80:83], v[168:171], v[28:31], v[80:83]
    global_load_dwordx4 v[168:171], v38, s[36:37] offset:2048 nt
    s_waitcnt vmcnt(47)
    v_mfma_f32_16x16x32_bf16 v[80:83], v[172:175], v[32:35], v[80:83]
    global_load_dwordx4 v[172:175], v39, s[36:37] offset:2048 nt
    s_waitcnt vmcnt(47)
    v_mfma_f32_16x16x32_bf16 v[84:87], v[176:179], v[20:23], 0
    global_load_dwordx4 v[176:179], v36, s[36:37] offset:3072 nt
    s_waitcnt vmcnt(47)
    v_mfma_f32_16x16x32_bf16 v[84:87], v[180:183], v[24:27], v[84:87]
    global_load_dwordx4 v[180:183], v37, s[36:37] offset:3072 nt
    s_waitcnt vmcnt(47)
    v_mfma_f32_16x16x32_bf16 v[84:87], v[184:187], v[28:31], v[84:87]
    s_waitcnt vmcnt(46)
    v_mfma_f32_16x16x32_bf16 v[84:87], v[188:191], v[32:35], v[84:87]
    s_waitcnt vmcnt(8)
    ds_read_b128 v[128:131], v51 offset:0
    ds_read_b128 v[132:135], v51 offset:1024
    ds_read_b128 v[136:139], v51 offset:2048
    ds_read_b128 v[140:143], v51 offset:3072
    ds_read_b128 v[144:147], v51 offset:4096
    ds_read_b128 v[148:151], v51 offset:5120
    v_mov_b32_dpp v64, v72 quad_perm:[0,0,0,0] row_mask:0xf bank_mask:0xf
    v_mov_b32_dpp v65, v76 quad_perm:[0,0,0,0] row_mask:0xf bank_mask:0xf
    v_mov_b32_dpp v66, v80 quad_perm:[0,0,0,0] row_mask:0xf bank_mask:0xf
    v_mov_b32_dpp v67, v84 quad_perm:[0,0,0,0] row_mask:0xf bank_mask:0xf
    v_add_f32_dpp v64, v73, v64 quad_perm:[1,1,1,1] row_mask:0xf bank_mask:0xf
    v_add_f32_dpp v65, v77, v65 quad_perm:[1,1,1,1] row_mask:0xf bank_mask:0xf
    v_add_f32_dpp v66, v81, v66 quad_perm:[1,1,1,1] row_mask:0xf bank_mask:0xf
    v_add_f32_dpp v67, v85, v67 quad_perm:[1,1,1,1] row_mask:0xf bank_mask:0xf
    v_add_f32_dpp v64, v74, v64 quad_perm:[2,2,2,2] row_mask:0xf bank_mask:0xf
    v_add_f32_dpp v65, v78, v65 quad_perm:[2,2,2,2] row_mask:0xf bank_mask:0xf
    v_add_f32_dpp v66, v82, v66 quad_perm:[2,2,2,2] row_mask:0xf bank_mask:0xf
    v_add_f32_dpp v67, v86, v67 quad_perm:[2,2,2,2] row_mask:0xf bank_mask:0xf
    v_add_f32_dpp v64, v75, v64 quad_perm:[3,3,3,3] row_mask:0xf bank_mask:0xf
    v_add_f32_dpp v65, v79, v65 quad_perm:[3,3,3,3] row_mask:0xf bank_mask:0xf
    v_add_f32_dpp v66, v83, v66 quad_perm:[3,3,3,3] row_mask:0xf bank_mask:0xf
    v_add_f32_dpp v67, v87, v67 quad_perm:[3,3,3,3] row_mask:0xf bank_mask:0xf
    v_cvt_pk_bf16_f32 v68, v64, v65
    v_lshlrev_b32 v64, 16, v68
    v_and_b32 v65, s55, v68
    v_cvt_pk_bf16_f32 v69, v66, v67
    v_lshlrev_b32 v66, 16, v69
    v_and_b32 v67, s55, v69
    v_mul_f32 v64, s54, v64
    v_mul_f32 v65, s54, v65
    v_mul_f32 v66, s54, v66
    v_mul_f32 v67, s54, v67
    v_cvt_pk_bf16_f32 v44, v64, v65
    v_cvt_pk_bf16_f32 v45, v66, v67
    s_waitcnt lgkmcnt(0)
    s_lshl_b32 s4, s90, 7
    v_add_u32 v1, s4, v15
    s_mov_b32 exec_lo, 0x11111111
    s_mov_b32 exec_hi, 0x11111111
    ds_write_b64 v1, v[44:45]
    s_mov_b64 exec, -1
    s_add_u32 s90, s90, 1
    v_mfma_f32_16x16x32_bf16 v[72:75], v[192:195], v[20:23], 0
    v_mfma_f32_16x16x32_bf16 v[72:75], v[196:199], v[24:27], v[72:75]
    v_mfma_f32_16x16x32_bf16 v[72:75], v[200:203], v[28:31], v[72:75]
    v_mfma_f32_16x16x32_bf16 v[72:75], v[204:207], v[32:35], v[72:75]
    v_mfma_f32_16x16x32_bf16 v[76:79], v[208:211], v[20:23], 0
    v_mfma_f32_16x16x32_bf16 v[76:79], v[212:215], v[24:27], v[76:79]
    v_mfma_f32_16x16x32_bf16 v[76:79], v[216:219], v[28:31], v[76:79]
    ds_read_b128 v[192:195], v51 offset:6144
    v_mfma_f32_16x16x32_bf16 v[76:79], v[220:223], v[32:35], v[76:79]
    ds_read_b128 v[196:199], v51 offset:7168
    v_mfma_f32_16x16x32_bf16 v[80:83], v[224:227], v[20:23], 0
    ds_read_b128 v[200:203], v51 offset:8192
    v_mfma_f32_16x16x32_bf16 v[80:83], v[228:231], v[24:27], v[80:83]
    ds_read_b128 v[204:207], v51 offset:9216
    v_mfma_f32_16x16x32_bf16 v[80:83], v[232:235], v[28:31], v[80:83]
    ds_read_b128 v[208:211], v51 offset:10240
    v_mfma_f32_16x16x32_bf16 v[80:83], v[236:239], v[32:35], v[80:83]
    ds_read_b128 v[212:215], v51 offset:11264
    v_mfma_f32_16x16x32_bf16 v[84:87], v[240:243], v[20:23], 0
    v_mfma_f32_16x16x32_bf16 v[84:87], v[244:247], v[24:27], v[84:87]
    v_mfma_f32_16x16x32_bf16 v[84:87], v[248:251], v[28:31], v[84:87]
    v_mfma_f32_16x16x32_bf16 v[84:87], v[252:255], v[32:35], v[84:87]
    v_mov_b32_dpp v64, v72 quad_perm:[0,0,0,0] row_mask:0xf bank_mask:0xf
    v_mov_b32_dpp v65, v76 quad_perm:[0,0,0,0] row_mask:0xf bank_mask:0xf
    s_nop 0
    v_mov_b32_dpp v66, v80 quad_perm:[0,0,0,0] row_mask:0xf bank_mask:0xf
    s_nop 3
    v_mov_b32_dpp v67, v84 quad_perm:[0,0,0,0] row_mask:0xf bank_mask:0xf
    v_add_f32_dpp v64, v73, v64 quad_perm:[1,1,1,1] row_mask:0xf bank_mask:0xf
    v_add_f32_dpp v65, v77, v65 quad_perm:[1,1,1,1] row_mask:0xf bank_mask:0xf
    v_add_f32_dpp v66, v81, v66 quad_perm:[1,1,1,1] row_mask:0xf bank_mask:0xf
    v_add_f32_dpp v67, v85, v67 quad_perm:[1,1,1,1] row_mask:0xf bank_mask:0xf
    v_add_f32_dpp v64, v74, v64 quad_perm:[2,2,2,2] row_mask:0xf bank_mask:0xf
    v_add_f32_dpp v65, v78, v65 quad_perm:[2,2,2,2] row_mask:0xf bank_mask:0xf
    v_add_f32_dpp v66, v82, v66 quad_perm:[2,2,2,2] row_mask:0xf bank_mask:0xf
    v_add_f32_dpp v67, v86, v67 quad_perm:[2,2,2,2] row_mask:0xf bank_mask:0xf
    v_add_f32_dpp v64, v75, v64 quad_perm:[3,3,3,3] row_mask:0xf bank_mask:0xf
    v_add_f32_dpp v65, v79, v65 quad_perm:[3,3,3,3] row_mask:0xf bank_mask:0xf
    v_add_f32_dpp v66, v83, v66 quad_perm:[3,3,3,3] row_mask:0xf bank_mask:0xf
    v_add_f32_dpp v67, v87, v67 quad_perm:[3,3,3,3] row_mask:0xf bank_mask:0xf
    v_cvt_pk_bf16_f32 v68, v64, v65
    v_lshlrev_b32 v64, 16, v68
    v_and_b32 v65, s55, v68
    v_cvt_pk_bf16_f32 v69, v66, v67
    v_lshlrev_b32 v66, 16, v69
    v_and_b32 v67, s55, v69
    v_mul_f32 v64, s54, v64
    v_mul_f32 v65, s54, v65
    v_mul_f32 v66, s54, v66
    v_mul_f32 v67, s54, v67
    v_cvt_pk_bf16_f32 v44, v64, v65
    v_cvt_pk_bf16_f32 v45, v66, v67
    s_lshl_b32 s4, s90, 7
    v_add_u32 v1, s4, v15
    s_mov_b32 exec_lo, 0x11111111
    s_mov_b32 exec_hi, 0x11111111
    ds_write_b64 v1, v[44:45]
    s_mov_b64 exec, -1
    s_add_u32 s90, s90, 1
    v_mfma_f32_16x16x32_bf16 v[72:75], v[88:91], v[20:23], 0
    v_mfma_f32_16x16x32_bf16 v[72:75], v[92:95], v[24:27], v[72:75]
    v_mfma_f32_16x16x32_bf16 v[72:75], v[96:99], v[28:31], v[72:75]
    v_mfma_f32_16x16x32_bf16 v[72:75], v[100:103], v[32:35], v[72:75]
    v_mfma_f32_16x16x32_bf16 v[76:79], v[104:107], v[20:23], 0
    v_mfma_f32_16x16x32_bf16 v[76:79], v[108:111], v[24:27], v[76:79]
    v_mfma_f32_16x16x32_bf16 v[76:79], v[112:115], v[28:31], v[76:79]
    v_mfma_f32_16x16x32_bf16 v[76:79], v[116:119], v[32:35], v[76:79]
    v_mfma_f32_16x16x32_bf16 v[80:83], v[120:123], v[20:23], 0
    v_mfma_f32_16x16x32_bf16 v[80:83], v[124:127], v[24:27], v[80:83]
    s_waitcnt lgkmcnt(0)
    v_mfma_f32_16x16x32_bf16 v[80:83], v[192:195], v[28:31], v[80:83]
    v_mfma_f32_16x16x32_bf16 v[80:83], v[196:199], v[32:35], v[80:83]
    v_mfma_f32_16x16x32_bf16 v[84:87], v[200:203], v[20:23], 0
    v_mfma_f32_16x16x32_bf16 v[84:87], v[204:207], v[24:27], v[84:87]
    v_mfma_f32_16x16x32_bf16 v[84:87], v[208:211], v[28:31], v[84:87]
    v_mfma_f32_16x16x32_bf16 v[84:87], v[212:215], v[32:35], v[84:87]
    v_mov_b32_dpp v64, v72 quad_perm:[0,0,0,0] row_mask:0xf bank_mask:0xf
    v_mov_b32_dpp v65, v76 quad_perm:[0,0,0,0] row_mask:0xf bank_mask:0xf
    s_nop 1
    v_mov_b32_dpp v66, v80 quad_perm:[0,0,0,0] row_mask:0xf bank_mask:0xf
    s_nop 2
    v_mov_b32_dpp v67, v84 quad_perm:[0,0,0,0] row_mask:0xf bank_mask:0xf
    v_add_f32_dpp v64, v73, v64 quad_perm:[1,1,1,1] row_mask:0xf bank_mask:0xf
    v_add_f32_dpp v65, v77, v65 quad_perm:[1,1,1,1] row_mask:0xf bank_mask:0xf
    v_add_f32_dpp v66, v81, v66 quad_perm:[1,1,1,1] row_mask:0xf bank_mask:0xf
    v_add_f32_dpp v67, v85, v67 quad_perm:[1,1,1,1] row_mask:0xf bank_mask:0xf
    v_add_f32_dpp v64, v74, v64 quad_perm:[2,2,2,2] row_mask:0xf bank_mask:0xf
    v_add_f32_dpp v65, v78, v65 quad_perm:[2,2,2,2] row_mask:0xf bank_mask:0xf
    v_add_f32_dpp v66, v82, v66 quad_perm:[2,2,2,2] row_mask:0xf bank_mask:0xf
    v_add_f32_dpp v67, v86, v67 quad_perm:[2,2,2,2] row_mask:0xf bank_mask:0xf
    v_add_f32_dpp v64, v75, v64 quad_perm:[3,3,3,3] row_mask:0xf bank_mask:0xf
    v_add_f32_dpp v65, v79, v65 quad_perm:[3,3,3,3] row_mask:0xf bank_mask:0xf
    v_add_f32_dpp v66, v83, v66 quad_perm:[3,3,3,3] row_mask:0xf bank_mask:0xf
    v_add_f32_dpp v67, v87, v67 quad_perm:[3,3,3,3] row_mask:0xf bank_mask:0xf
    v_cvt_pk_bf16_f32 v68, v64, v65
    v_lshlrev_b32 v64, 16, v68
    v_and_b32 v65, s55, v68
    v_cvt_pk_bf16_f32 v69, v66, v67
    v_lshlrev_b32 v66, 16, v69
    v_and_b32 v67, s55, v69
    v_mul_f32 v64, s54, v64
    v_mul_f32 v65, s54, v65
    v_mul_f32 v66, s54, v66
    v_mul_f32 v67, s54, v67
    v_cvt_pk_bf16_f32 v44, v64, v65
    v_cvt_pk_bf16_f32 v45, v66, v67
    s_lshl_b32 s4, s90, 7
    v_add_u32 v1, s4, v15
    s_mov_b32 exec_lo, 0x11111111
    s_mov_b32 exec_hi, 0x11111111
    ds_write_b64 v1, v[44:45]
    s_mov_b64 exec, -1
    s_add_u32 s90, s90, 1
    s_mov_b32 s49, s47
    s_mov_b32 m0, s90
    v_writelane_b32 v14, s49, m0
    v_mfma_f32_16x16x32_bf16 v[72:75], v[128:131], v[20:23], 0
    v_mfma_f32_16x16x32_bf16 v[72:75], v[132:135], v[24:27], v[72:75]
    v_mfma_f32_16x16x32_bf16 v[72:75], v[136:139], v[28:31], v[72:75]
    v_mfma_f32_16x16x32_bf16 v[72:75], v[140:143], v[32:35], v[72:75]
    v_mfma_f32_16x16x32_bf16 v[76:79], v[144:147], v[20:23], 0
    v_mfma_f32_16x16x32_bf16 v[76:79], v[148:151], v[24:27], v[76:79]
    s_branch L_kmid
L_kloop:
    s_mov_b32 s49, s47
    s_and_b32 s4, s49, 255
    s_cmp_lt_u32 s4, 32
    s_cbranch_scc1 L_knolist
    s_mov_b32 m0, s90
    v_writelane_b32 v14, s49, m0
L_knolist:
    s_cmp_lg_u32 s14, 0
    s_cbranch_scc1 L_kfull
L_dc0k:
    s_cmp_lg_u32 s10, 0
    s_cbranch_scc1 L_deck
    v_mov_b32 v1, 11088
    ds_read_b64 v[2:3], v1
    s_waitcnt lgkmcnt(0)
    v_readfirstlane_b32 s4, v2
    v_readfirstlane_b32 s5, v3
    s_nop 0
    s_and_b32 s6, s4, s5
    s_bitcmp0_b32 s6, 1
    s_cbranch_scc1 L_deck
    s_mov_b32 s10, 1
    s_or_b32 s6, s4, s5
    s_cmp_gt_u32 s6, 3
    s_cbranch_scc1 L_deck
    s_xor_b32 s11, s4, s5
    s_and_b32 s48, s4, 1
    s_and_b32 s12, s5, 1
    s_cmp_lg_u32 s17, 0
    s_cbranch_scc1 L_deck
    s_lshl_b32 s15, s48, 8
    s_lshl_b32 s16, s48, 2
L_deck:
    s_mov_b32 s46, 512
    s_cmp_ge_u32 s90, 44
    s_cbranch_scc1 L_kfull
    s_mov_b32 s46, 1
    s_atomic_add s46, s[44:45], s16 glc
L_kfull:
    s_waitcnt vmcnt(7)
    v_mfma_f32_16x16x32_bf16 v[72:75], v[128:131], v[20:23], 0
    global_load_dwordx4 v[160:163], v36, s[36:37] offset:2048 nt
    s_waitcnt vmcnt(7)
    v_mfma_f32_16x16x32_bf16 v[72:75], v[132:135], v[24:27], v[72:75]
    global_load_dwordx4 v[164:167], v37, s[36:37] offset:2048 nt
    s_waitcnt vmcnt(7)
    v_mfma_f32_16x16x32_bf16 v[72:75], v[136:139], v[28:31], v[72:75]
    global_load_dwordx4 v[168:171], v38, s[36:37] offset:2048 nt
    s_waitcnt vmcnt(7)
    v_mfma_f32_16x16x32_bf16 v[72:75], v[140:143], v[32:35], v[72:75]
    global_load_dwordx4 v[172:175], v39, s[36:37] offset:2048 nt
    s_waitcnt vmcnt(7)
    v_mfma_f32_16x16x32_bf16 v[76:79], v[144:147], v[20:23], 0
    global_load_dwordx4 v[176:179], v36, s[36:37] offset:3072 nt
    s_waitcnt vmcnt(7)
    v_mfma_f32_16x16x32_bf16 v[76:79], v[148:151], v[24:27], v[76:79]
    global_load_dwordx4 v[180:183], v37, s[36:37] offset:3072 nt
L_kmid:
    s_waitcnt vmcnt(7)
    v_mfma_f32_16x16x32_bf16 v[76:79], v[152:155], v[28:31], v[76:79]
    global_load_dwordx4 v[184:187], v38, s[36:37] offset:3072 nt
    s_waitcnt vmcnt(7)
    v_mfma_f32_16x16x32_bf16 v[76:79], v[156:159], v[32:35], v[76:79]
    global_load_dwordx4 v[188:191], v39, s[36:37] offset:3072 nt
    s_cmp_eq_u32 s14, 0
    s_cbranch_scc1 L_ktk
    s_sub_u32 s14, s14, 1
    s_add_u32 s47, s47, 8
    s_branch L_kset
L_ktk:
    s_waitcnt lgkmcnt(0)
    s_cmp_lt_u32 s46, 64
    s_cbranch_scc1 L_kgot
    s_cmp_lg_u32 s17, 0
    s_cbranch_scc1 L_kfin
    s_mov_b32 s17, 1
    s_xor_b32 s15, s15, 256
    s_xor_b32 s16, s16, 4
    s_cmp_ge_u32 s90, 44
    s_cbranch_scc1 L_kfin
    s_mov_b32 s46, 1
    s_atomic_add s46, s[44:45], s16 glc
    s_branch L_ktk
L_kgot:
    s_mov_b32 s4, 0
    s_mov_b32 s5, 0
    s_mov_b32 s14, 1
    s_cmp_ge_u32 s46, 32
    s_cselect_b32 s4, 32, s4
    s_cselect_b32 s5, 64, s5
    s_cselect_b32 s14, 14, s14
    s_cmp_ge_u32 s46, 40
    s_cselect_b32 s4, 40, s4
    s_cselect_b32 s5, 176, s5
    s_cselect_b32 s14, 6, s14
    s_cmp_ge_u32 s46, 48
    s_cselect_b32 s4, 48, s4
    s_cselect_b32 s5, 224, s5
    s_cselect_b32 s14, 3, s14
    s_cmp_ge_u32 s46, 56
    s_cselect_b32 s4, 56, s4
    s_cselect_b32 s5, 248, s5
    s_cselect_b32 s14, 1, s14
    s_sub_u32 s4, s46, s4
    s_and_b32 s6, s4, 7
    s_sub_u32 s4, s4, s6
    s_mul_i32 s4, s4, s14
    s_add_u32 s4, s4, s6
    s_add_u32 s47, s4, s5
    s_sub_u32 s14, s14, 1
    s_add_u32 s47, s47, s15
L_kset:
    s_xor_b32 s6, s47, s68
    s_bfe_u32 s4, s6, 0x10000
    s_lshl_b32 s4, s4, 9
    s_bfe_u32 s5, s6, 0x20001
    s_lshl_b32 s5, s5, 16
    s_or_b32 s4, s4, s5
    s_bfe_u32 s5, s6, 0x20003
    s_lshl_b32 s5, s5, 21
    s_or_b32 s4, s4, s5
    s_bfe_u32 s5, s6, 0x10005
    s_lshl_b32 s5, s5, 20
    s_or_b32 s4, s4, s5
    s_bfe_u32 s5, s6, 0x10006
    s_lshl_b32 s5, s5, 19
    s_or_b32 s4, s4, s5
    s_bfe_u32 s5, s6, 0x10007
    s_lshl_b32 s5, s5, 18
    s_or_b32 s4, s4, s5
    s_bfe_u32 s5, s6, 0x10008
    s_lshl_b32 s5, s5, 13
    s_or_b32 s4, s4, s5
    s_lshr_b32 s5, s4, 8
    s_and_b32 s5, s5, 8192
    s_xor_b32 s4, s4, s5
    s_add_u32 s36, s40, s4
    s_addc_u32 s37, s41, 0
    s_waitcnt vmcnt(7)
    v_mfma_f32_16x16x32_bf16 v[80:83], v[160:163], v[20:23], 0
    global_load_dwordx4 v[128:131], v36, s[36:37] offset:0 nt
    s_waitcnt vmcnt(7)
    v_mfma_f32_16x16x32_bf16 v[80:83], v[164:167], v[24:27], v[80:83]
    global_load_dwordx4 v[132:135], v37, s[36:37] offset:0 nt
    s_waitcnt vmcnt(7)
    v_mfma_f32_16x16x32_bf16 v[80:83], v[168:171], v[28:31], v[80:83]
    global_load_dwordx4 v[136:139], v38, s[36:37] offset:0 nt
    s_waitcnt vmcnt(7)
    v_mfma_f32_16x16x32_bf16 v[80:83], v[172:175], v[32:35], v[80:83]
    global_load_dwordx4 v[140:143], v39, s[36:37] offset:0 nt
    s_waitcnt vmcnt(7)
    v_mfma_f32_16x16x32_bf16 v[84:87], v[176:179], v[20:23], 0
    global_load_dwordx4 v[144:147], v36, s[36:37] offset:1024 nt
    s_waitcnt vmcnt(7)
    v_mfma_f32_16x16x32_bf16 v[84:87], v[180:183], v[24:27], v[84:87]
    global_load_dwordx4 v[148:151], v37, s[36:37] offset:1024 nt
    s_waitcnt vmcnt(7)
    v_mfma_f32_16x16x32_bf16 v[84:87], v[184:187], v[28:31], v[84:87]
    global_load_dwordx4 v[152:155], v38, s[36:37] offset:1024 nt
    s_waitcnt vmcnt(7)
    v_mfma_f32_16x16x32_bf16 v[84:87], v[188:191], v[32:35], v[84:87]
    global_load_dwordx4 v[156:159], v39, s[36:37] offset:1024 nt
    v_mov_b32_dpp v64, v72 quad_perm:[0,0,0,0] row_mask:0xf bank_mask:0xf
    v_mov_b32_dpp v65, v76 quad_perm:[0,0,0,0] row_mask:0xf bank_mask:0xf
    v_mov_b32_dpp v66, v80 quad_perm:[0,0,0,0] row_mask:0xf bank_mask:0xf
    s_nop 3
    v_mov_b32_dpp v67, v84 quad_perm:[0,0,0,0] row_mask:0xf bank_mask:0xf
    v_add_f32_dpp v64, v73, v64 quad_perm:[1,1,1,1] row_mask:0xf bank_mask:0xf
    v_add_f32_dpp v65, v77, v65 quad_perm:[1,1,1,1] row_mask:0xf bank_mask:0xf
    v_add_f32_dpp v66, v81, v66 quad_perm:[1,1,1,1] row_mask:0xf bank_mask:0xf
    v_add_f32_dpp v67, v85, v67 quad_perm:[1,1,1,1] row_mask:0xf bank_mask:0xf
    v_add_f32_dpp v64, v74, v64 quad_perm:[2,2,2,2] row_mask:0xf bank_mask:0xf
    v_add_f32_dpp v65, v78, v65 quad_perm:[2,2,2,2] row_mask:0xf bank_mask:0xf
    v_add_f32_dpp v66, v82, v66 quad_perm:[2,2,2,2] row_mask:0xf bank_mask:0xf
    v_add_f32_dpp v67, v86, v67 quad_perm:[2,2,2,2] row_mask:0xf bank_mask:0xf
    v_add_f32_dpp v64, v75, v64 quad_perm:[3,3,3,3] row_mask:0xf bank_mask:0xf
    v_add_f32_dpp v65, v79, v65 quad_perm:[3,3,3,3] row_mask:0xf bank_mask:0xf
    v_add_f32_dpp v66, v83, v66 quad_perm:[3,3,3,3] row_mask:0xf bank_mask:0xf
    v_add_f32_dpp v67, v87, v67 quad_perm:[3,3,3,3] row_mask:0xf bank_mask:0xf
    v_cvt_pk_bf16_f32 v68, v64, v65
    v_lshlrev_b32 v64, 16, v68
    v_and_b32 v65, s55, v68
    v_cvt_pk_bf16_f32 v69, v66, v67
    v_lshlrev_b32 v66, 16, v69
    v_and_b32 v67, s55, v69
    v_mul_f32 v64, s54, v64
    v_mul_f32 v65, s54, v65
    v_mul_f32 v66, s54, v66
    v_mul_f32 v67, s54, v67
    v_cvt_pk_bf16_f32 v44, v64, v65
    v_cvt_pk_bf16_f32 v45, v66, v67
    s_and_b32 s4, s49, 255
    s_cmp_lt_u32 s4, 32
    s_cbranch_scc1 L_pp_k
    s_lshl_b32 s4, s90, 7
    v_add_u32 v1, s4, v15
    s_mov_b32 exec_lo, 0x11111111
    s_mov_b32 exec_hi, 0x11111111
    ds_write_b64 v1, v[44:45]
    s_mov_b64 exec, -1
    s_add_u32 s90, s90, 1
    s_branch L_pd_k
L_pp_k:
    s_cmp_lg_u32 s92, 0
    s_cbranch_scc1 L_pc_k
    v_mov_b32 v1, 11084
L_lw_3:
    ds_read_b32 v2, v1
    s_waitcnt lgkmcnt(0)
    v_cmp_gt_u32 vcc, 1, v2
    s_cbranch_vccnz L_lw_3
    s_mov_b32 s92, 1
L_pc_k:
    v_min_u32 v44, -2, v44
    v_min_u32 v45, -2, v45
    s_lshr_b32 s4, s49, 8
    s_mul_i32 s4, s4, 32
    s_and_b32 s5, s49, 255
    s_add_u32 s4, s4, s5
    s_lshl_b32 s4, s4, 7
    v_add_u32 v1, s4, v46
    s_mov_b32 exec_lo, 0x11111111
    s_mov_b32 exec_hi, 0x11111111
    global_store_dwordx2 v1, v[44:45], s[94:95] sc1
    s_mov_b64 exec, -1
L_pd_k:
    s_branch L_kloop
L_kfin:
    v_bfe_u32 v1, v0, 4, 1
    v_lshlrev_b32 v1, 8, v1
    v_lshrrev_b32 v2, 5, v0
    v_lshl_add_u32 v1, v2, 15, v1
    v_and_b32 v2, 15, v0
    v_lshl_add_u32 v36, v2, 4, v1
    v_add_u32 v37, 4096, v36
    v_add_u32 v38, 16384, v36
    v_add_u32 v39, 20480, v36
    v_readlane_b32 s47, v14, 0
    s_nop 0
    s_xor_b32 s6, s47, s68
    s_bfe_u32 s4, s6, 0x10000
    s_lshl_b32 s4, s4, 9
    s_bfe_u32 s5, s6, 0x20001
    s_lshl_b32 s5, s5, 16
    s_or_b32 s4, s4, s5
    s_bfe_u32 s5, s6, 0x20003
    s_lshl_b32 s5, s5, 21
    s_or_b32 s4, s4, s5
    s_bfe_u32 s5, s6, 0x10005
    s_lshl_b32 s5, s5, 20
    s_or_b32 s4, s4, s5
    s_bfe_u32 s5, s6, 0x10006
    s_lshl_b32 s5, s5, 19
    s_or_b32 s4, s4, s5
    s_bfe_u32 s5, s6, 0x10007
    s_lshl_b32 s5, s5, 18
    s_or_b32 s4, s4, s5
    s_bfe_u32 s5, s6, 0x10008
    s_lshl_b32 s5, s5, 13
    s_or_b32 s4, s4, s5
    s_lshr_b32 s5, s4, 8
    s_and_b32 s5, s5, 8192
    s_xor_b32 s4, s4, s5
    s_add_u32 s38, s42, s4
    s_addc_u32 s39, s43, 0
    s_waitcnt vmcnt(7)
    v_mfma_f32_16x16x32_bf16 v[80:83], v[160:163], v[20:23], 0
    global_load_dwordx4 v[128:131], v36, s[38:39] offset:0 nt
    s_waitcnt vmcnt(7)
    v_mfma_f32_16x16x32_bf16 v[80:83], v[164:167], v[24:27], v[80:83]
    global_load_dwordx4 v[132:135], v37, s[38:39] offset:0 nt
    s_waitcnt vmcnt(7)
    v_mfma_f32_16x16x32_bf16 v[80:83], v[168:171], v[28:31], v[80:83]
    global_load_dwordx4 v[136:139], v38, s[38:39] offset:0 nt
    s_waitcnt vmcnt(7)
    v_mfma_f32_16x16x32_bf16 v[80:83], v[172:175], v[32:35], v[80:83]
    global_load_dwordx4 v[140:143], v39, s[38:39] offset:0 nt
    s_waitcnt vmcnt(7)
    v_mfma_f32_16x16x32_bf16 v[84:87], v[176:179], v[20:23], 0
    global_load_dwordx4 v[144:147], v36, s[38:39] offset:1024 nt
    s_waitcnt vmcnt(7)
    v_mfma_f32_16x16x32_bf16 v[84:87], v[180:183], v[24:27], v[84:87]
    global_load_dwordx4 v[148:151], v37, s[38:39] offset:1024 nt
    s_waitcnt vmcnt(7)
    v_mfma_f32_16x16x32_bf16 v[84:87], v[184:187], v[28:31], v[84:87]
    global_load_dwordx4 v[152:155], v38, s[38:39] offset:1024 nt
    s_waitcnt vmcnt(7)
    v_mfma_f32_16x16x32_bf16 v[84:87], v[188:191], v[32:35], v[84:87]
    global_load_dwordx4 v[156:159], v39, s[38:39] offset:1024 nt
    v_mov_b32_dpp v64, v72 quad_perm:[0,0,0,0] row_mask:0xf bank_mask:0xf
    v_mov_b32_dpp v65, v76 quad_perm:[0,0,0,0] row_mask:0xf bank_mask:0xf
    v_mov_b32_dpp v66, v80 quad_perm:[0,0,0,0] row_mask:0xf bank_mask:0xf
    s_nop 3
    v_mov_b32_dpp v67, v84 quad_perm:[0,0,0,0] row_mask:0xf bank_mask:0xf
    v_add_f32_dpp v64, v73, v64 quad_perm:[1,1,1,1] row_mask:0xf bank_mask:0xf
    v_add_f32_dpp v65, v77, v65 quad_perm:[1,1,1,1] row_mask:0xf bank_mask:0xf
    v_add_f32_dpp v66, v81, v66 quad_perm:[1,1,1,1] row_mask:0xf bank_mask:0xf
    v_add_f32_dpp v67, v85, v67 quad_perm:[1,1,1,1] row_mask:0xf bank_mask:0xf
    v_add_f32_dpp v64, v74, v64 quad_perm:[2,2,2,2] row_mask:0xf bank_mask:0xf
    v_add_f32_dpp v65, v78, v65 quad_perm:[2,2,2,2] row_mask:0xf bank_mask:0xf
    v_add_f32_dpp v66, v82, v66 quad_perm:[2,2,2,2] row_mask:0xf bank_mask:0xf
    v_add_f32_dpp v67, v86, v67 quad_perm:[2,2,2,2] row_mask:0xf bank_mask:0xf
    v_add_f32_dpp v64, v75, v64 quad_perm:[3,3,3,3] row_mask:0xf bank_mask:0xf
    v_add_f32_dpp v65, v79, v65 quad_perm:[3,3,3,3] row_mask:0xf bank_mask:0xf
    v_add_f32_dpp v66, v83, v66 quad_perm:[3,3,3,3] row_mask:0xf bank_mask:0xf
    v_add_f32_dpp v67, v87, v67 quad_perm:[3,3,3,3] row_mask:0xf bank_mask:0xf
    v_cvt_pk_bf16_f32 v68, v64, v65
    v_lshlrev_b32 v64, 16, v68
    v_and_b32 v65, s55, v68
    v_cvt_pk_bf16_f32 v69, v66, v67
    v_lshlrev_b32 v66, 16, v69
    v_and_b32 v67, s55, v69
    v_mul_f32 v64, s54, v64
    v_mul_f32 v65, s54, v65
    v_mul_f32 v66, s54, v66
    v_mul_f32 v67, s54, v67
    v_cvt_pk_bf16_f32 v44, v64, v65
    v_cvt_pk_bf16_f32 v45, v66, v67
    s_and_b32 s4, s49, 255
    s_cmp_lt_u32 s4, 32
    s_cbranch_scc1 L_pp_f
    s_lshl_b32 s4, s90, 7
    v_add_u32 v1, s4, v15
    s_mov_b32 exec_lo, 0x11111111
    s_mov_b32 exec_hi, 0x11111111
    ds_write_b64 v1, v[44:45]
    s_mov_b64 exec, -1
    s_add_u32 s90, s90, 1
    s_branch L_pd_f
L_pp_f:
    s_cmp_lg_u32 s92, 0
    s_cbranch_scc1 L_pc_f
    v_mov_b32 v1, 11084
L_lw_4:
    ds_read_b32 v2, v1
    s_waitcnt lgkmcnt(0)
    v_cmp_gt_u32 vcc, 1, v2
    s_cbranch_vccnz L_lw_4
    s_mov_b32 s92, 1
L_pc_f:
    v_min_u32 v44, -2, v44
    v_min_u32 v45, -2, v45
    s_lshr_b32 s4, s49, 8
    s_mul_i32 s4, s4, 32
    s_and_b32 s5, s49, 255
    s_add_u32 s4, s4, s5
    s_lshl_b32 s4, s4, 7
    v_add_u32 v1, s4, v46
    s_mov_b32 exec_lo, 0x11111111
    s_mov_b32 exec_hi, 0x11111111
    global_store_dwordx2 v1, v[44:45], s[94:95] sc1
    s_mov_b64 exec, -1
L_pd_f:
L_vstart:
    v_mov_b32 v1, 11084
L_lw_5:
    ds_read_b32 v2, v1
    s_waitcnt lgkmcnt(0)
    v_cmp_gt_u32 vcc, 1, v2
    s_cbranch_vccnz L_lw_5
    s_mov_b32 s17, 1
L_dc0v:
    s_cmp_lg_u32 s10, 0
    s_cbranch_scc1 L_decv
    v_mov_b32 v1, 11088
    ds_read_b64 v[2:3], v1
    s_waitcnt lgkmcnt(0)
    v_readfirstlane_b32 s4, v2
    v_readfirstlane_b32 s5, v3
    s_nop 0
    s_and_b32 s6, s4, s5
    s_bitcmp0_b32 s6, 1
    s_cbranch_scc1 L_dc0v
    s_mov_b32 s10, 1
    s_or_b32 s6, s4, s5
    s_cmp_gt_u32 s6, 3
    s_cbranch_scc1 L_decv
    s_xor_b32 s11, s4, s5
    s_and_b32 s48, s4, 1
    s_and_b32 s12, s5, 1
    s_cmp_lg_u32 s17, 0
    s_cbranch_scc1 L_decv
    s_lshl_b32 s15, s48, 8
    s_lshl_b32 s16, s48, 2
L_decv:
    s_cmp_eq_u32 s11, 0
    s_cbranch_scc1 L_xe
    s_lshl_b32 s4, s64, 2
    s_xor_b32 s5, s93, 0
    s_add_u32 s4, s4, s5
    s_lshl_b32 s4, s4, 2
    s_add_u32 s4, s4, s70
    s_lshl_b32 s5, s4, 2
    s_add_u32 s5, s5, 53248
    s_mul_i32 s4, s4, 7424
    s_add_u32 s4, s4, 16781312
    s_add_u32 s22, s34, s5
    s_addc_u32 s23, s35, 0
    s_add_u32 s24, s34, s4
    s_addc_u32 s25, s35, 0
    s_mul_i32 s4, s70, 12288
    s_add_u32 s4, s4, 115200
    v_lshl_add_u32 v2, v0, 4, s4
    ds_read_b128 v[88:91], v2 offset:0
    ds_read_b128 v[92:95], v2 offset:1024
    ds_read_b128 v[96:99], v2 offset:2048
    s_cmp_le_u32 s90, 28
    s_cbranch_scc1 L_xpr
    ds_read_b128 v[100:103], v2 offset:3072
    s_cmp_le_u32 s90, 36
    s_cbranch_scc1 L_xpr
    ds_read_b128 v[104:107], v2 offset:4096
    s_cmp_le_u32 s90, 44
    s_cbranch_scc1 L_xpr
    ds_read_b128 v[108:111], v2 offset:5120
    s_cmp_le_u32 s90, 52
    s_cbranch_scc1 L_xpr
    ds_read_b128 v[112:115], v2 offset:6144
L_xpr:
    v_lshlrev_b32 v1, 4, v0
    v_lshlrev_b32 v3, 2, v0
    s_waitcnt lgkmcnt(0)
    global_store_dword v3, v14, s[24:25] offset:-4096 sc1
    global_store_dwordx4 v1, v[88:91], s[24:25] offset:-3840 sc1
    global_store_dwordx4 v1, v[92:95], s[24:25] offset:-2816 sc1
    global_store_dwordx4 v1, v[96:99], s[24:25] offset:-1792 sc1
    s_cmp_le_u32 s90, 28
    s_cbranch_scc1 L_xps
    global_store_dwordx4 v1, v[100:103], s[24:25] offset:-768 sc1
    s_cmp_le_u32 s90, 36
    s_cbranch_scc1 L_xps
    global_store_dwordx4 v1, v[104:107], s[24:25] offset:256 sc1
    s_cmp_le_u32 s90, 44
    s_cbranch_scc1 L_xps
    global_store_dwordx4 v1, v[108:111], s[24:25] offset:1280 sc1
    s_cmp_le_u32 s90, 52
    s_cbranch_scc1 L_xps
    global_store_dwordx4 v1, v[112:115], s[24:25] offset:2304 sc1
L_xps:
L_xe:
    s_mov_b32 s48, s12
    s_lshl_b32 s15, s48, 8
    s_lshl_b32 s16, s48, 2
    s_add_u32 s16, s16, 128
    s_mov_b32 s91, 1
    s_mov_b32 s92, 0
    s_mov_b32 s17, 0
    s_mov_b32 s26, 0
    s_cmp_lg_u32 s11, 0
    s_cbranch_scc1 L_vx
L_vloop:
    s_cmp_lg_u32 s92, 0
    s_cbranch_scc1 L_vp_a
    s_sub_u32 s4, s91, 1
    s_lshl_b32 s4, s4, 7
    v_add_u32 v1, s4, v15
    ds_read_b64 v[44:45], v1
    s_waitcnt lgkmcnt(0)
    s_branch L_vs_a
L_vp_a:
    s_waitcnt vmcnt(8)
    v_max_u32 v1, v48, v49
    v_cmp_eq_u32 vcc, -1, v1
    s_cbranch_vccnz L_vslow_a
L_vq_a:
    v_mov_b32 v44, v48
    v_mov_b32 v45, v49
L_vs_a:
    v_lshlrev_b32 v64, 16, v44
    v_and_b32 v65, s55, v44
    v_lshlrev_b32 v66, 16, v45
    v_and_b32 v67, s55, v45
    v_mul_f32 v64, s53, v64
    v_mul_f32 v65, s53, v65
    v_mul_f32 v66, s53, v66
    v_mul_f32 v67, s53, v67
    v_max3_f32 v68, v64, v65, v66
    v_max_f32 v68, v68, v67
    v_cmp_gt_f32 vcc, v68, v12
    s_cbranch_vccnz L_resc_a
L_cont_a:
    v_sub_f32 v64, v64, v12
    v_sub_f32 v65, v65, v12
    v_sub_f32 v66, v66, v12
    v_sub_f32 v67, v67, v12
    v_exp_f32 v64, v64
    v_exp_f32 v65, v65
    v_exp_f32 v66, v66
    v_exp_f32 v67, v67
    v_cvt_pk_bf16_f32 v52, v64, v64
    v_cvt_pk_bf16_f32 v53, v65, v65
    v_cvt_pk_bf16_f32 v54, v66, v66
    v_cvt_pk_bf16_f32 v55, v67, v67
    v_add_f32 v64, v64, v65
    v_add_f32 v66, v66, v67
    v_add_f32 v13, v13, v64
    v_add_f32 v13, v13, v66
    v_and_b32_dpp v56, v52, v8 row_newbcast:0 row_mask:0xf bank_mask:0xf
    v_and_b32_dpp v57, v52, v9 row_newbcast:0 row_mask:0xf bank_mask:0xf
    v_and_b32_dpp v58, v52, v10 row_newbcast:0 row_mask:0xf bank_mask:0xf
    v_and_b32_dpp v59, v52, v11 row_newbcast:0 row_mask:0xf bank_mask:0xf
    s_cmp_eq_u32 s11, 0
    s_cbranch_scc1 L_xba
    s_cmp_lg_u32 s91, 3
    s_cbranch_scc1 L_xba
    s_lshl_b32 s4, s64, 2
    s_xor_b32 s5, s93, 2
    s_add_u32 s4, s4, s5
    s_lshl_b32 s4, s4, 2
    s_add_u32 s4, s4, s70
    s_lshl_b32 s5, s4, 2
    s_add_u32 s5, s5, 53248
    s_mul_i32 s4, s4, 7424
    s_add_u32 s4, s4, 16781312
    s_add_u32 s22, s34, s5
    s_addc_u32 s23, s35, 0
    s_add_u32 s24, s34, s4
    s_addc_u32 s25, s35, 0
    s_load_dword s13, s[22:23], 0 glc
L_xba:
    s_cmp_lt_u32 s91, s90
    s_cbranch_scc1 L_vna_a
    s_mov_b32 s46, 1
    s_atomic_add s46, s[44:45], s16 glc
L_vna_a:
    v_and_b32_dpp v60, v52, v8 row_newbcast:4 row_mask:0xf bank_mask:0xf
    v_and_b32_dpp v61, v52, v9 row_newbcast:4 row_mask:0xf bank_mask:0xf
    v_and_b32_dpp v62, v52, v10 row_newbcast:4 row_mask:0xf bank_mask:0xf
    v_and_b32_dpp v63, v52, v11 row_newbcast:4 row_mask:0xf bank_mask:0xf
    s_waitcnt vmcnt(7)
    v_mfma_f32_16x16x32_bf16 v[16:19], v[128:131], v[56:59], v[16:19]
    global_load_dwordx4 v[160:163], v36, s[38:39] offset:2048 nt
    v_and_b32_dpp v56, v52, v8 row_newbcast:8 row_mask:0xf bank_mask:0xf
    v_and_b32_dpp v57, v52, v9 row_newbcast:8 row_mask:0xf bank_mask:0xf
    v_and_b32_dpp v58, v52, v10 row_newbcast:8 row_mask:0xf bank_mask:0xf
    v_and_b32_dpp v59, v52, v11 row_newbcast:8 row_mask:0xf bank_mask:0xf
    s_waitcnt vmcnt(7)
    v_mfma_f32_16x16x32_bf16 v[16:19], v[132:135], v[60:63], v[16:19]
    global_load_dwordx4 v[164:167], v37, s[38:39] offset:2048 nt
    v_and_b32_dpp v60, v52, v8 row_newbcast:12 row_mask:0xf bank_mask:0xf
    v_and_b32_dpp v61, v52, v9 row_newbcast:12 row_mask:0xf bank_mask:0xf
    v_and_b32_dpp v62, v52, v10 row_newbcast:12 row_mask:0xf bank_mask:0xf
    v_and_b32_dpp v63, v52, v11 row_newbcast:12 row_mask:0xf bank_mask:0xf
    s_waitcnt vmcnt(7)
    v_mfma_f32_16x16x32_bf16 v[16:19], v[136:139], v[56:59], v[16:19]
    global_load_dwordx4 v[168:171], v38, s[38:39] offset:2048 nt
    v_and_b32_dpp v56, v53, v8 row_newbcast:0 row_mask:0xf bank_mask:0xf
    v_and_b32_dpp v57, v53, v9 row_newbcast:0 row_mask:0xf bank_mask:0xf
    v_and_b32_dpp v58, v53, v10 row_newbcast:0 row_mask:0xf bank_mask:0xf
    v_and_b32_dpp v59, v53, v11 row_newbcast:0 row_mask:0xf bank_mask:0xf
    s_waitcnt vmcnt(7)
    v_mfma_f32_16x16x32_bf16 v[16:19], v[140:143], v[60:63], v[16:19]
    global_load_dwordx4 v[172:175], v39, s[38:39] offset:2048 nt
    v_and_b32_dpp v60, v53, v8 row_newbcast:4 row_mask:0xf bank_mask:0xf
    v_and_b32_dpp v61, v53, v9 row_newbcast:4 row_mask:0xf bank_mask:0xf
    v_and_b32_dpp v62, v53, v10 row_newbcast:4 row_mask:0xf bank_mask:0xf
    v_and_b32_dpp v63, v53, v11 row_newbcast:4 row_mask:0xf bank_mask:0xf
    s_waitcnt vmcnt(7)
    v_mfma_f32_16x16x32_bf16 v[16:19], v[144:147], v[56:59], v[16:19]
    global_load_dwordx4 v[176:179], v36, s[38:39] offset:3072 nt
    v_and_b32_dpp v56, v53, v8 row_newbcast:8 row_mask:0xf bank_mask:0xf
    v_and_b32_dpp v57, v53, v9 row_newbcast:8 row_mask:0xf bank_mask:0xf
    v_and_b32_dpp v58, v53, v10 row_newbcast:8 row_mask:0xf bank_mask:0xf
    v_and_b32_dpp v59, v53, v11 row_newbcast:8 row_mask:0xf bank_mask:0xf
    s_waitcnt vmcnt(7)
    v_mfma_f32_16x16x32_bf16 v[16:19], v[148:151], v[60:63], v[16:19]
    global_load_dwordx4 v[180:183], v37, s[38:39] offset:3072 nt
    v_and_b32_dpp v60, v53, v8 row_newbcast:12 row_mask:0xf bank_mask:0xf
    v_and_b32_dpp v61, v53, v9 row_newbcast:12 row_mask:0xf bank_mask:0xf
    v_and_b32_dpp v62, v53, v10 row_newbcast:12 row_mask:0xf bank_mask:0xf
    v_and_b32_dpp v63, v53, v11 row_newbcast:12 row_mask:0xf bank_mask:0xf
    s_waitcnt vmcnt(7)
    v_mfma_f32_16x16x32_bf16 v[16:19], v[152:155], v[56:59], v[16:19]
    global_load_dwordx4 v[184:187], v38, s[38:39] offset:3072 nt
    v_and_b32_dpp v56, v54, v8 row_newbcast:0 row_mask:0xf bank_mask:0xf
    v_and_b32_dpp v57, v54, v9 row_newbcast:0 row_mask:0xf bank_mask:0xf
    v_and_b32_dpp v58, v54, v10 row_newbcast:0 row_mask:0xf bank_mask:0xf
    v_and_b32_dpp v59, v54, v11 row_newbcast:0 row_mask:0xf bank_mask:0xf
    s_waitcnt vmcnt(7)
    v_mfma_f32_16x16x32_bf16 v[16:19], v[156:159], v[60:63], v[16:19]
    global_load_dwordx4 v[188:191], v39, s[38:39] offset:3072 nt
    s_cmp_lt_u32 s91, s90
    s_cbranch_scc0 L_vnp_a
    s_mov_b32 m0, s91
    v_readlane_b32 s47, v14, m0
    s_add_u32 s91, s91, 1
    s_branch L_vnn_a
L_vnp_a:
    s_waitcnt lgkmcnt(0)
    s_cmp_lt_u32 s46, 32
    s_cbranch_scc1 L_vgot_a
    s_add_u32 s17, s17, 1
    s_cmp_ge_u32 s17, 2
    s_cbranch_scc1 L_fin_a
    s_xor_b32 s4, s48, s17
    s_lshl_b32 s15, s4, 8
    s_lshl_b32 s16, s4, 2
    s_add_u32 s16, s16, 128
    s_mov_b32 s46, 1
    s_atomic_add s46, s[44:45], s16 glc
    s_branch L_vnp_a
L_vgot_a:
    s_add_u32 s47, s46, s15
    s_mov_b32 s92, 1
    s_lshr_b32 s4, s47, 8
    s_mul_i32 s4, s4, 32
    s_and_b32 s5, s47, 255
    s_add_u32 s4, s4, s5
    s_lshl_b32 s4, s4, 7
    v_add_u32 v50, s4, v46
    global_load_dwordx2 v[48:49], v50, s[94:95] sc1
L_vnn_a:
    s_xor_b32 s6, s47, s68
    s_bfe_u32 s4, s6, 0x10000
    s_lshl_b32 s4, s4, 9
    s_bfe_u32 s5, s6, 0x20001
    s_lshl_b32 s5, s5, 16
    s_or_b32 s4, s4, s5
    s_bfe_u32 s5, s6, 0x20003
    s_lshl_b32 s5, s5, 21
    s_or_b32 s4, s4, s5
    s_bfe_u32 s5, s6, 0x10005
    s_lshl_b32 s5, s5, 20
    s_or_b32 s4, s4, s5
    s_bfe_u32 s5, s6, 0x10006
    s_lshl_b32 s5, s5, 19
    s_or_b32 s4, s4, s5
    s_bfe_u32 s5, s6, 0x10007
    s_lshl_b32 s5, s5, 18
    s_or_b32 s4, s4, s5
    s_bfe_u32 s5, s6, 0x10008
    s_lshl_b32 s5, s5, 13
    s_or_b32 s4, s4, s5
    s_lshr_b32 s5, s4, 8
    s_and_b32 s5, s5, 8192
    s_xor_b32 s4, s4, s5
    s_add_u32 s38, s42, s4
    s_addc_u32 s39, s43, 0
    v_and_b32_dpp v60, v54, v8 row_newbcast:4 row_mask:0xf bank_mask:0xf
    v_and_b32_dpp v61, v54, v9 row_newbcast:4 row_mask:0xf bank_mask:0xf
    v_and_b32_dpp v62, v54, v10 row_newbcast:4 row_mask:0xf bank_mask:0xf
    v_and_b32_dpp v63, v54, v11 row_newbcast:4 row_mask:0xf bank_mask:0xf
    s_waitcnt vmcnt(7)
    v_mfma_f32_16x16x32_bf16 v[16:19], v[160:163], v[56:59], v[16:19]
    global_load_dwordx4 v[128:131], v36, s[38:39] offset:0 nt
    v_and_b32_dpp v56, v54, v8 row_newbcast:8 row_mask:0xf bank_mask:0xf
    v_and_b32_dpp v57, v54, v9 row_newbcast:8 row_mask:0xf bank_mask:0xf
    v_and_b32_dpp v58, v54, v10 row_newbcast:8 row_mask:0xf bank_mask:0xf
    v_and_b32_dpp v59, v54, v11 row_newbcast:8 row_mask:0xf bank_mask:0xf
    s_waitcnt vmcnt(7)
    v_mfma_f32_16x16x32_bf16 v[16:19], v[164:167], v[60:63], v[16:19]
    global_load_dwordx4 v[132:135], v37, s[38:39] offset:0 nt
    v_and_b32_dpp v60, v54, v8 row_newbcast:12 row_mask:0xf bank_mask:0xf
    v_and_b32_dpp v61, v54, v9 row_newbcast:12 row_mask:0xf bank_mask:0xf
    v_and_b32_dpp v62, v54, v10 row_newbcast:12 row_mask:0xf bank_mask:0xf
    v_and_b32_dpp v63, v54, v11 row_newbcast:12 row_mask:0xf bank_mask:0xf
    s_waitcnt vmcnt(7)
    v_mfma_f32_16x16x32_bf16 v[16:19], v[168:171], v[56:59], v[16:19]
    global_load_dwordx4 v[136:139], v38, s[38:39] offset:0 nt
    v_and_b32_dpp v56, v55, v8 row_newbcast:0 row_mask:0xf bank_mask:0xf
    v_and_b32_dpp v57, v55, v9 row_newbcast:0 row_mask:0xf bank_mask:0xf
    v_and_b32_dpp v58, v55, v10 row_newbcast:0 row_mask:0xf bank_mask:0xf
    v_and_b32_dpp v59, v55, v11 row_newbcast:0 row_mask:0xf bank_mask:0xf
    s_waitcnt vmcnt(7)
    v_mfma_f32_16x16x32_bf16 v[16:19], v[172:175], v[60:63], v[16:19]
    global_load_dwordx4 v[140:143], v39, s[38:39] offset:0 nt
    v_and_b32_dpp v60, v55, v8 row_newbcast:4 row_mask:0xf bank_mask:0xf
    v_and_b32_dpp v61, v55, v9 row_newbcast:4 row_mask:0xf bank_mask:0xf
    v_and_b32_dpp v62, v55, v10 row_newbcast:4 row_mask:0xf bank_mask:0xf
    v_and_b32_dpp v63, v55, v11 row_newbcast:4 row_mask:0xf bank_mask:0xf
    s_waitcnt vmcnt(7)
    v_mfma_f32_16x16x32_bf16 v[16:19], v[176:179], v[56:59], v[16:19]
    global_load_dwordx4 v[144:147], v36, s[38:39] offset:1024 nt
    v_and_b32_dpp v56, v55, v8 row_newbcast:8 row_mask:0xf bank_mask:0xf
    v_and_b32_dpp v57, v55, v9 row_newbcast:8 row_mask:0xf bank_mask:0xf
    v_and_b32_dpp v58, v55, v10 row_newbcast:8 row_mask:0xf bank_mask:0xf
    v_and_b32_dpp v59, v55, v11 row_newbcast:8 row_mask:0xf bank_mask:0xf
    s_waitcnt vmcnt(7)
    v_mfma_f32_16x16x32_bf16 v[16:19], v[180:183], v[60:63], v[16:19]
    global_load_dwordx4 v[148:151], v37, s[38:39] offset:1024 nt
    v_and_b32_dpp v60, v55, v8 row_newbcast:12 row_mask:0xf bank_mask:0xf
    v_and_b32_dpp v61, v55, v9 row_newbcast:12 row_mask:0xf bank_mask:0xf
    v_and_b32_dpp v62, v55, v10 row_newbcast:12 row_mask:0xf bank_mask:0xf
    v_and_b32_dpp v63, v55, v11 row_newbcast:12 row_mask:0xf bank_mask:0xf
    s_waitcnt vmcnt(7)
    v_mfma_f32_16x16x32_bf16 v[16:19], v[184:187], v[56:59], v[16:19]
    global_load_dwordx4 v[152:155], v38, s[38:39] offset:1024 nt
    s_waitcnt vmcnt(7)
    v_mfma_f32_16x16x32_bf16 v[16:19], v[188:191], v[60:63], v[16:19]
    global_load_dwordx4 v[156:159], v39, s[38:39] offset:1024 nt
    s_cmp_lg_u32 s11, 2
    s_cbranch_scc1 L_xsa
    s_cmp_lg_u32 s91, 4
    s_cbranch_scc1 L_xsa
    s_mov_b32 s52, 262144
L_xwa:
    s_waitcnt lgkmcnt(0)
    s_cmp_lg_u32 s13, 0
    s_cbranch_scc1 L_xga
    s_load_dword s13, s[22:23], 0 glc
    s_sub_u32 s52, s52, 1
    s_cmp_lg_u32 s52, 0
    s_cbranch_scc1 L_xwa
    s_waitcnt lgkmcnt(0)
L_xga:
    s_and_b32 s90, s13, 0x3f
    s_mov_b32 s11, 3
    v_lshlrev_b32 v1, 4, v0
    v_lshlrev_b32 v3, 2, v0
    global_load_dword v120, v3, s[24:25] offset:-4096 sc1
    global_load_dwordx4 v[88:91], v1, s[24:25] offset:-3840 sc1
    global_load_dwordx4 v[92:95], v1, s[24:25] offset:-2816 sc1
    global_load_dwordx4 v[96:99], v1, s[24:25] offset:-1792 sc1
    s_cmp_le_u32 s90, 28
    s_cbranch_scc1 L_xpla
    global_load_dwordx4 v[100:103], v1, s[24:25] offset:-768 sc1
    s_cmp_le_u32 s90, 36
    s_cbranch_scc1 L_xpla
    global_load_dwordx4 v[104:107], v1, s[24:25] offset:256 sc1
    s_cmp_le_u32 s90, 44
    s_cbranch_scc1 L_xpla
    global_load_dwordx4 v[108:111], v1, s[24:25] offset:1280 sc1
    s_cmp_le_u32 s90, 52
    s_cbranch_scc1 L_xpla
    global_load_dwordx4 v[112:115], v1, s[24:25] offset:2304 sc1
L_xpla:
L_xsa:
    s_cmp_eq_u32 s11, 3
    s_cbranch_scc1 L_vx
L_vctl:
    s_cmp_eq_u32 s92, 0
    s_cbranch_scc1 L_vloop
    s_cmp_lg_u32 s17, 0
    s_cbranch_scc1 L_vdeep
    s_cmp_lt_u32 s46, 32
    s_cbranch_scc1 L_vloop
L_vdeep:
    global_load_dwordx4 v[160:163], v36, s[38:39] offset:2048 nt
    global_load_dwordx4 v[164:167], v37, s[38:39] offset:2048 nt
    global_load_dwordx4 v[168:171], v38, s[38:39] offset:2048 nt
    global_load_dwordx4 v[172:175], v39, s[38:39] offset:2048 nt
    global_load_dwordx4 v[176:179], v36, s[38:39] offset:3072 nt
    global_load_dwordx4 v[180:183], v37, s[38:39] offset:3072 nt
    global_load_dwordx4 v[184:187], v38, s[38:39] offset:3072 nt
    global_load_dwordx4 v[188:191], v39, s[38:39] offset:3072 nt
    s_cmp_lg_u32 s92, 0
    s_cbranch_scc1 L_vp_b
    s_sub_u32 s4, s91, 1
    s_lshl_b32 s4, s4, 7
    v_add_u32 v1, s4, v15
    ds_read_b64 v[44:45], v1
    s_waitcnt lgkmcnt(0)
    s_branch L_vs_b
L_vp_b:
    s_waitcnt vmcnt(16)
    v_max_u32 v1, v48, v49
    v_cmp_eq_u32 vcc, -1, v1
    s_cbranch_vccnz L_vslow_b
L_vq_b:
    v_mov_b32 v44, v48
    v_mov_b32 v45, v49
L_vs_b:
    v_lshlrev_b32 v64, 16, v44
    v_and_b32 v65, s55, v44
    v_lshlrev_b32 v66, 16, v45
    v_and_b32 v67, s55, v45
    v_mul_f32 v64, s53, v64
    v_mul_f32 v65, s53, v65
    v_mul_f32 v66, s53, v66
    v_mul_f32 v67, s53, v67
    v_max3_f32 v68, v64, v65, v66
    v_max_f32 v68, v68, v67
    v_cmp_gt_f32 vcc, v68, v12
    s_cbranch_vccnz L_resc_b
L_cont_b:
    v_sub_f32 v64, v64, v12
    v_sub_f32 v65, v65, v12
    v_sub_f32 v66, v66, v12
    v_sub_f32 v67, v67, v12
    v_exp_f32 v64, v64
    v_exp_f32 v65, v65
    v_exp_f32 v66, v66
    v_exp_f32 v67, v67
    v_cvt_pk_bf16_f32 v52, v64, v64
    v_cvt_pk_bf16_f32 v53, v65, v65
    v_cvt_pk_bf16_f32 v54, v66, v66
    v_cvt_pk_bf16_f32 v55, v67, v67
    v_add_f32 v64, v64, v65
    v_add_f32 v66, v66, v67
    v_add_f32 v13, v13, v64
    v_add_f32 v13, v13, v66
    v_and_b32_dpp v56, v52, v8 row_newbcast:0 row_mask:0xf bank_mask:0xf
    v_and_b32_dpp v57, v52, v9 row_newbcast:0 row_mask:0xf bank_mask:0xf
    v_and_b32_dpp v58, v52, v10 row_newbcast:0 row_mask:0xf bank_mask:0xf
    v_and_b32_dpp v59, v52, v11 row_newbcast:0 row_mask:0xf bank_mask:0xf
    s_cmp_lt_u32 s91, s90
    s_cbranch_scc1 L_vna_b
    s_mov_b32 s46, 1
    s_atomic_add s46, s[44:45], s16 glc
L_vna_b:
    v_and_b32_dpp v60, v52, v8 row_newbcast:4 row_mask:0xf bank_mask:0xf
    v_and_b32_dpp v61, v52, v9 row_newbcast:4 row_mask:0xf bank_mask:0xf
    v_and_b32_dpp v62, v52, v10 row_newbcast:4 row_mask:0xf bank_mask:0xf
    v_and_b32_dpp v63, v52, v11 row_newbcast:4 row_mask:0xf bank_mask:0xf
    s_waitcnt vmcnt(15)
    v_mfma_f32_16x16x32_bf16 v[16:19], v[128:131], v[56:59], v[16:19]
    v_and_b32_dpp v56, v52, v8 row_newbcast:8 row_mask:0xf bank_mask:0xf
    v_and_b32_dpp v57, v52, v9 row_newbcast:8 row_mask:0xf bank_mask:0xf
    v_and_b32_dpp v58, v52, v10 row_newbcast:8 row_mask:0xf bank_mask:0xf
    v_and_b32_dpp v59, v52, v11 row_newbcast:8 row_mask:0xf bank_mask:0xf
    s_waitcnt vmcnt(14)
    v_mfma_f32_16x16x32_bf16 v[16:19], v[132:135], v[60:63], v[16:19]
    v_and_b32_dpp v60, v52, v8 row_newbcast:12 row_mask:0xf bank_mask:0xf
    v_and_b32_dpp v61, v52, v9 row_newbcast:12 row_mask:0xf bank_mask:0xf
    v_and_b32_dpp v62, v52, v10 row_newbcast:12 row_mask:0xf bank_mask:0xf
    v_and_b32_dpp v63, v52, v11 row_newbcast:12 row_mask:0xf bank_mask:0xf
    s_waitcnt vmcnt(13)
    v_mfma_f32_16x16x32_bf16 v[16:19], v[136:139], v[56:59], v[16:19]
    v_and_b32_dpp v56, v53, v8 row_newbcast:0 row_mask:0xf bank_mask:0xf
    v_and_b32_dpp v57, v53, v9 row_newbcast:0 row_mask:0xf bank_mask:0xf
    v_and_b32_dpp v58, v53, v10 row_newbcast:0 row_mask:0xf bank_mask:0xf
    v_and_b32_dpp v59, v53, v11 row_newbcast:0 row_mask:0xf bank_mask:0xf
    s_waitcnt vmcnt(12)
    v_mfma_f32_16x16x32_bf16 v[16:19], v[140:143], v[60:63], v[16:19]
    v_and_b32_dpp v60, v53, v8 row_newbcast:4 row_mask:0xf bank_mask:0xf
    v_and_b32_dpp v61, v53, v9 row_newbcast:4 row_mask:0xf bank_mask:0xf
    v_and_b32_dpp v62, v53, v10 row_newbcast:4 row_mask:0xf bank_mask:0xf
    v_and_b32_dpp v63, v53, v11 row_newbcast:4 row_mask:0xf bank_mask:0xf
    s_waitcnt vmcnt(11)
    v_mfma_f32_16x16x32_bf16 v[16:19], v[144:147], v[56:59], v[16:19]
    v_and_b32_dpp v56, v53, v8 row_newbcast:8 row_mask:0xf bank_mask:0xf
    v_and_b32_dpp v57, v53, v9 row_newbcast:8 row_mask:0xf bank_mask:0xf
    v_and_b32_dpp v58, v53, v10 row_newbcast:8 row_mask:0xf bank_mask:0xf
    v_and_b32_dpp v59, v53, v11 row_newbcast:8 row_mask:0xf bank_mask:0xf
    s_waitcnt vmcnt(10)
    v_mfma_f32_16x16x32_bf16 v[16:19], v[148:151], v[60:63], v[16:19]
    v_and_b32_dpp v60, v53, v8 row_newbcast:12 row_mask:0xf bank_mask:0xf
    v_and_b32_dpp v61, v53, v9 row_newbcast:12 row_mask:0xf bank_mask:0xf
    v_and_b32_dpp v62, v53, v10 row_newbcast:12 row_mask:0xf bank_mask:0xf
    v_and_b32_dpp v63, v53, v11 row_newbcast:12 row_mask:0xf bank_mask:0xf
    s_waitcnt vmcnt(9)
    v_mfma_f32_16x16x32_bf16 v[16:19], v[152:155], v[56:59], v[16:19]
    v_and_b32_dpp v56, v54, v8 row_newbcast:0 row_mask:0xf bank_mask:0xf
    v_and_b32_dpp v57, v54, v9 row_newbcast:0 row_mask:0xf bank_mask:0xf
    v_and_b32_dpp v58, v54, v10 row_newbcast:0 row_mask:0xf bank_mask:0xf
    v_and_b32_dpp v59, v54, v11 row_newbcast:0 row_mask:0xf bank_mask:0xf
    s_waitcnt vmcnt(8)
    v_mfma_f32_16x16x32_bf16 v[16:19], v[156:159], v[60:63], v[16:19]
    s_cmp_lt_u32 s91, s90
    s_cbranch_scc0 L_vnp_b
    s_mov_b32 m0, s91
    v_readlane_b32 s47, v14, m0
    s_add_u32 s91, s91, 1
    s_branch L_vnn_b
L_vnp_b:
    s_waitcnt lgkmcnt(0)
    s_cmp_lt_u32 s46, 32
    s_cbranch_scc1 L_vgot_b
    s_add_u32 s17, s17, 1
    s_cmp_ge_u32 s17, 2
    s_cbranch_scc1 L_fin_b
    s_xor_b32 s4, s48, s17
    s_lshl_b32 s15, s4, 8
    s_lshl_b32 s16, s4, 2
    s_add_u32 s16, s16, 128
    s_mov_b32 s46, 1
    s_atomic_add s46, s[44:45], s16 glc
    s_branch L_vnp_b
L_vgot_b:
    s_add_u32 s47, s46, s15
    s_mov_b32 s92, 1
    s_lshr_b32 s4, s47, 8
    s_mul_i32 s4, s4, 32
    s_and_b32 s5, s47, 255
    s_add_u32 s4, s4, s5
    s_lshl_b32 s4, s4, 7
    v_add_u32 v50, s4, v46
    global_load_dwordx2 v[48:49], v50, s[94:95] sc1
L_vnn_b:
    s_xor_b32 s6, s47, s68
    s_bfe_u32 s4, s6, 0x10000
    s_lshl_b32 s4, s4, 9
    s_bfe_u32 s5, s6, 0x20001
    s_lshl_b32 s5, s5, 16
    s_or_b32 s4, s4, s5
    s_bfe_u32 s5, s6, 0x20003
    s_lshl_b32 s5, s5, 21
    s_or_b32 s4, s4, s5
    s_bfe_u32 s5, s6, 0x10005
    s_lshl_b32 s5, s5, 20
    s_or_b32 s4, s4, s5
    s_bfe_u32 s5, s6, 0x10006
    s_lshl_b32 s5, s5, 19
    s_or_b32 s4, s4, s5
    s_bfe_u32 s5, s6, 0x10007
    s_lshl_b32 s5, s5, 18
    s_or_b32 s4, s4, s5
    s_bfe_u32 s5, s6, 0x10008
    s_lshl_b32 s5, s5, 13
    s_or_b32 s4, s4, s5
    s_lshr_b32 s5, s4, 8
    s_and_b32 s5, s5, 8192
    s_xor_b32 s4, s4, s5
    s_add_u32 s38, s42, s4
    s_addc_u32 s39, s43, 0
    v_and_b32_dpp v60, v54, v8 row_newbcast:4 row_mask:0xf bank_mask:0xf
    v_and_b32_dpp v61, v54, v9 row_newbcast:4 row_mask:0xf bank_mask:0xf
    v_and_b32_dpp v62, v54, v10 row_newbcast:4 row_mask:0xf bank_mask:0xf
    v_and_b32_dpp v63, v54, v11 row_newbcast:4 row_mask:0xf bank_mask:0xf
    s_waitcnt vmcnt(7)
    v_mfma_f32_16x16x32_bf16 v[16:19], v[160:163], v[56:59], v[16:19]
    global_load_dwordx4 v[128:131], v36, s[38:39] offset:0 nt
    v_and_b32_dpp v56, v54, v8 row_newbcast:8 row_mask:0xf bank_mask:0xf
    v_and_b32_dpp v57, v54, v9 row_newbcast:8 row_mask:0xf bank_mask:0xf
    v_and_b32_dpp v58, v54, v10 row_newbcast:8 row_mask:0xf bank_mask:0xf
    v_and_b32_dpp v59, v54, v11 row_newbcast:8 row_mask:0xf bank_mask:0xf
    s_waitcnt vmcnt(7)
    v_mfma_f32_16x16x32_bf16 v[16:19], v[164:167], v[60:63], v[16:19]
    global_load_dwordx4 v[132:135], v37, s[38:39] offset:0 nt
    v_and_b32_dpp v60, v54, v8 row_newbcast:12 row_mask:0xf bank_mask:0xf
    v_and_b32_dpp v61, v54, v9 row_newbcast:12 row_mask:0xf bank_mask:0xf
    v_and_b32_dpp v62, v54, v10 row_newbcast:12 row_mask:0xf bank_mask:0xf
    v_and_b32_dpp v63, v54, v11 row_newbcast:12 row_mask:0xf bank_mask:0xf
    s_waitcnt vmcnt(7)
    v_mfma_f32_16x16x32_bf16 v[16:19], v[168:171], v[56:59], v[16:19]
    global_load_dwordx4 v[136:139], v38, s[38:39] offset:0 nt
    v_and_b32_dpp v56, v55, v8 row_newbcast:0 row_mask:0xf bank_mask:0xf
    v_and_b32_dpp v57, v55, v9 row_newbcast:0 row_mask:0xf bank_mask:0xf
    v_and_b32_dpp v58, v55, v10 row_newbcast:0 row_mask:0xf bank_mask:0xf
    v_and_b32_dpp v59, v55, v11 row_newbcast:0 row_mask:0xf bank_mask:0xf
    s_waitcnt vmcnt(7)
    v_mfma_f32_16x16x32_bf16 v[16:19], v[172:175], v[60:63], v[16:19]
    global_load_dwordx4 v[140:143], v39, s[38:39] offset:0 nt
    v_and_b32_dpp v60, v55, v8 row_newbcast:4 row_mask:0xf bank_mask:0xf
    v_and_b32_dpp v61, v55, v9 row_newbcast:4 row_mask:0xf bank_mask:0xf
    v_and_b32_dpp v62, v55, v10 row_newbcast:4 row_mask:0xf bank_mask:0xf
    v_and_b32_dpp v63, v55, v11 row_newbcast:4 row_mask:0xf bank_mask:0xf
    s_waitcnt vmcnt(7)
    v_mfma_f32_16x16x32_bf16 v[16:19], v[176:179], v[56:59], v[16:19]
    global_load_dwordx4 v[144:147], v36, s[38:39] offset:1024 nt
    v_and_b32_dpp v56, v55, v8 row_newbcast:8 row_mask:0xf bank_mask:0xf
    v_and_b32_dpp v57, v55, v9 row_newbcast:8 row_mask:0xf bank_mask:0xf
    v_and_b32_dpp v58, v55, v10 row_newbcast:8 row_mask:0xf bank_mask:0xf
    v_and_b32_dpp v59, v55, v11 row_newbcast:8 row_mask:0xf bank_mask:0xf
    s_waitcnt vmcnt(7)
    v_mfma_f32_16x16x32_bf16 v[16:19], v[180:183], v[60:63], v[16:19]
    global_load_dwordx4 v[148:151], v37, s[38:39] offset:1024 nt
    v_and_b32_dpp v60, v55, v8 row_newbcast:12 row_mask:0xf bank_mask:0xf
    v_and_b32_dpp v61, v55, v9 row_newbcast:12 row_mask:0xf bank_mask:0xf
    v_and_b32_dpp v62, v55, v10 row_newbcast:12 row_mask:0xf bank_mask:0xf
    v_and_b32_dpp v63, v55, v11 row_newbcast:12 row_mask:0xf bank_mask:0xf
    s_waitcnt vmcnt(7)
    v_mfma_f32_16x16x32_bf16 v[16:19], v[184:187], v[56:59], v[16:19]
    global_load_dwordx4 v[152:155], v38, s[38:39] offset:1024 nt
    s_waitcnt vmcnt(7)
    v_mfma_f32_16x16x32_bf16 v[16:19], v[188:191], v[60:63], v[16:19]
    global_load_dwordx4 v[156:159], v39, s[38:39] offset:1024 nt
    s_branch L_vdeep
L_vx:
    s_cmp_lg_u32 s92, 0
    s_cbranch_scc1 L_vp_x
    s_sub_u32 s4, s91, 1
    s_lshl_b32 s4, s4, 7
    v_add_u32 v1, s4, v15
    ds_read_b64 v[44:45], v1
    s_waitcnt lgkmcnt(0)
    s_branch L_vs_x
L_vp_x:
    s_waitcnt vmcnt(8)
    v_max_u32 v1, v48, v49
    v_cmp_eq_u32 vcc, -1, v1
    s_cbranch_vccnz L_vslow_x
L_vq_x:
    v_mov_b32 v44, v48
    v_mov_b32 v45, v49
L_vs_x:
    v_lshlrev_b32 v64, 16, v44
    v_and_b32 v65, s55, v44
    v_lshlrev_b32 v66, 16, v45
    v_and_b32 v67, s55, v45
    v_mul_f32 v64, s53, v64
    v_mul_f32 v65, s53, v65
    v_mul_f32 v66, s53, v66
    v_mul_f32 v67, s53, v67
    v_max3_f32 v68, v64, v65, v66
    v_max_f32 v68, v68, v67
    v_cmp_gt_f32 vcc, v68, v12
    s_cbranch_vccnz L_resc_x
L_cont_x:
    v_sub_f32 v64, v64, v12
    v_sub_f32 v65, v65, v12
    v_sub_f32 v66, v66, v12
    v_sub_f32 v67, v67, v12
    v_exp_f32 v64, v64
    v_exp_f32 v65, v65
    v_exp_f32 v66, v66
    v_exp_f32 v67, v67
    v_cvt_pk_bf16_f32 v52, v64, v64
    v_cvt_pk_bf16_f32 v53, v65, v65
    v_cvt_pk_bf16_f32 v54, v66, v66
    v_cvt_pk_bf16_f32 v55, v67, v67
    v_add_f32 v64, v64, v65
    v_add_f32 v66, v66, v67
    v_add_f32 v13, v13, v64
    v_add_f32 v13, v13, v66
    v_and_b32_dpp v56, v52, v8 row_newbcast:0 row_mask:0xf bank_mask:0xf
    v_and_b32_dpp v57, v52, v9 row_newbcast:0 row_mask:0xf bank_mask:0xf
    v_and_b32_dpp v58, v52, v10 row_newbcast:0 row_mask:0xf bank_mask:0xf
    v_and_b32_dpp v59, v52, v11 row_newbcast:0 row_mask:0xf bank_mask:0xf
    s_cmp_lt_u32 s91, s90
    s_cbranch_scc1 L_vna_x
    s_mov_b32 s46, 1
    s_atomic_add s46, s[44:45], s16 glc
L_vna_x:
    v_and_b32_dpp v60, v52, v8 row_newbcast:4 row_mask:0xf bank_mask:0xf
    v_and_b32_dpp v61, v52, v9 row_newbcast:4 row_mask:0xf bank_mask:0xf
    v_and_b32_dpp v62, v52, v10 row_newbcast:4 row_mask:0xf bank_mask:0xf
    v_and_b32_dpp v63, v52, v11 row_newbcast:4 row_mask:0xf bank_mask:0xf
    s_waitcnt vmcnt(11)
    v_mfma_f32_16x16x32_bf16 v[16:19], v[128:131], v[56:59], v[16:19]
    global_load_dwordx4 v[160:163], v36, s[38:39] offset:2048 nt
    v_and_b32_dpp v56, v52, v8 row_newbcast:8 row_mask:0xf bank_mask:0xf
    v_and_b32_dpp v57, v52, v9 row_newbcast:8 row_mask:0xf bank_mask:0xf
    v_and_b32_dpp v58, v52, v10 row_newbcast:8 row_mask:0xf bank_mask:0xf
    v_and_b32_dpp v59, v52, v11 row_newbcast:8 row_mask:0xf bank_mask:0xf
    s_waitcnt vmcnt(11)
    v_mfma_f32_16x16x32_bf16 v[16:19], v[132:135], v[60:63], v[16:19]
    global_load_dwordx4 v[164:167], v37, s[38:39] offset:2048 nt
    v_and_b32_dpp v60, v52, v8 row_newbcast:12 row_mask:0xf bank_mask:0xf
    v_and_b32_dpp v61, v52, v9 row_newbcast:12 row_mask:0xf bank_mask:0xf
    v_and_b32_dpp v62, v52, v10 row_newbcast:12 row_mask:0xf bank_mask:0xf
    v_and_b32_dpp v63, v52, v11 row_newbcast:12 row_mask:0xf bank_mask:0xf
    s_waitcnt vmcnt(11)
    v_mfma_f32_16x16x32_bf16 v[16:19], v[136:139], v[56:59], v[16:19]
    global_load_dwordx4 v[168:171], v38, s[38:39] offset:2048 nt
    v_and_b32_dpp v56, v53, v8 row_newbcast:0 row_mask:0xf bank_mask:0xf
    v_and_b32_dpp v57, v53, v9 row_newbcast:0 row_mask:0xf bank_mask:0xf
    v_and_b32_dpp v58, v53, v10 row_newbcast:0 row_mask:0xf bank_mask:0xf
    v_and_b32_dpp v59, v53, v11 row_newbcast:0 row_mask:0xf bank_mask:0xf
    s_waitcnt vmcnt(11)
    v_mfma_f32_16x16x32_bf16 v[16:19], v[140:143], v[60:63], v[16:19]
    global_load_dwordx4 v[172:175], v39, s[38:39] offset:2048 nt
    v_and_b32_dpp v60, v53, v8 row_newbcast:4 row_mask:0xf bank_mask:0xf
    v_and_b32_dpp v61, v53, v9 row_newbcast:4 row_mask:0xf bank_mask:0xf
    v_and_b32_dpp v62, v53, v10 row_newbcast:4 row_mask:0xf bank_mask:0xf
    v_and_b32_dpp v63, v53, v11 row_newbcast:4 row_mask:0xf bank_mask:0xf
    s_waitcnt vmcnt(11)
    v_mfma_f32_16x16x32_bf16 v[16:19], v[144:147], v[56:59], v[16:19]
    global_load_dwordx4 v[176:179], v36, s[38:39] offset:3072 nt
    v_and_b32_dpp v56, v53, v8 row_newbcast:8 row_mask:0xf bank_mask:0xf
    v_and_b32_dpp v57, v53, v9 row_newbcast:8 row_mask:0xf bank_mask:0xf
    v_and_b32_dpp v58, v53, v10 row_newbcast:8 row_mask:0xf bank_mask:0xf
    v_and_b32_dpp v59, v53, v11 row_newbcast:8 row_mask:0xf bank_mask:0xf
    s_waitcnt vmcnt(11)
    v_mfma_f32_16x16x32_bf16 v[16:19], v[148:151], v[60:63], v[16:19]
    global_load_dwordx4 v[180:183], v37, s[38:39] offset:3072 nt
    v_and_b32_dpp v60, v53, v8 row_newbcast:12 row_mask:0xf bank_mask:0xf
    v_and_b32_dpp v61, v53, v9 row_newbcast:12 row_mask:0xf bank_mask:0xf
    v_and_b32_dpp v62, v53, v10 row_newbcast:12 row_mask:0xf bank_mask:0xf
    v_and_b32_dpp v63, v53, v11 row_newbcast:12 row_mask:0xf bank_mask:0xf
    s_waitcnt vmcnt(11)
    v_mfma_f32_16x16x32_bf16 v[16:19], v[152:155], v[56:59], v[16:19]
    global_load_dwordx4 v[184:187], v38, s[38:39] offset:3072 nt
    v_and_b32_dpp v56, v54, v8 row_newbcast:0 row_mask:0xf bank_mask:0xf
    v_and_b32_dpp v57, v54, v9 row_newbcast:0 row_mask:0xf bank_mask:0xf
    v_and_b32_dpp v58, v54, v10 row_newbcast:0 row_mask:0xf bank_mask:0xf
    v_and_b32_dpp v59, v54, v11 row_newbcast:0 row_mask:0xf bank_mask:0xf
    s_waitcnt vmcnt(11)
    v_mfma_f32_16x16x32_bf16 v[16:19], v[156:159], v[60:63], v[16:19]
    global_load_dwordx4 v[188:191], v39, s[38:39] offset:3072 nt
    s_cmp_lg_u32 s11, 3
    s_cbranch_scc1 L_xmx
    s_waitcnt vmcnt(8)
    s_mul_i32 s4, s70, 12288
    s_add_u32 s4, s4, 115200
    v_lshl_add_u32 v2, v0, 4, s4
    v_mov_b32 v14, v120
    ds_write_b128 v2, v[88:91] offset:0
    ds_write_b128 v2, v[92:95] offset:1024
    ds_write_b128 v2, v[96:99] offset:2048
    s_cmp_le_u32 s90, 28
    s_cbranch_scc1 L_xpwx
    ds_write_b128 v2, v[100:103] offset:3072
    s_cmp_le_u32 s90, 36
    s_cbranch_scc1 L_xpwx
    ds_write_b128 v2, v[104:107] offset:4096
    s_cmp_le_u32 s90, 44
    s_cbranch_scc1 L_xpwx
    ds_write_b128 v2, v[108:111] offset:5120
    s_cmp_le_u32 s90, 52
    s_cbranch_scc1 L_xpwx
    ds_write_b128 v2, v[112:115] offset:6144
L_xpwx:
    s_mov_b32 s11, 0
L_xmx:
    s_cmp_lt_u32 s91, s90
    s_cbranch_scc0 L_vnp_x
    s_mov_b32 m0, s91
    v_readlane_b32 s47, v14, m0
    s_add_u32 s91, s91, 1
    s_branch L_vnn_x
L_vnp_x:
    s_waitcnt lgkmcnt(0)
    s_cmp_lt_u32 s46, 32
    s_cbranch_scc1 L_vgot_x
    s_add_u32 s17, s17, 1
    s_cmp_ge_u32 s17, 2
    s_cbranch_scc1 L_fin_x
    s_xor_b32 s4, s48, s17
    s_lshl_b32 s15, s4, 8
    s_lshl_b32 s16, s4, 2
    s_add_u32 s16, s16, 128
    s_mov_b32 s46, 1
    s_atomic_add s46, s[44:45], s16 glc
    s_branch L_vnp_x
L_vgot_x:
    s_add_u32 s47, s46, s15
    s_mov_b32 s92, 1
    s_lshr_b32 s4, s47, 8
    s_mul_i32 s4, s4, 32
    s_and_b32 s5, s47, 255
    s_add_u32 s4, s4, s5
    s_lshl_b32 s4, s4, 7
    v_add_u32 v50, s4, v46
    global_load_dwordx2 v[48:49], v50, s[94:95] sc1
L_vnn_x:
    s_xor_b32 s6, s47, s68
    s_bfe_u32 s4, s6, 0x10000
    s_lshl_b32 s4, s4, 9
    s_bfe_u32 s5, s6, 0x20001
    s_lshl_b32 s5, s5, 16
    s_or_b32 s4, s4, s5
    s_bfe_u32 s5, s6, 0x20003
    s_lshl_b32 s5, s5, 21
    s_or_b32 s4, s4, s5
    s_bfe_u32 s5, s6, 0x10005
    s_lshl_b32 s5, s5, 20
    s_or_b32 s4, s4, s5
    s_bfe_u32 s5, s6, 0x10006
    s_lshl_b32 s5, s5, 19
    s_or_b32 s4, s4, s5
    s_bfe_u32 s5, s6, 0x10007
    s_lshl_b32 s5, s5, 18
    s_or_b32 s4, s4, s5
    s_bfe_u32 s5, s6, 0x10008
    s_lshl_b32 s5, s5, 13
    s_or_b32 s4, s4, s5
    s_lshr_b32 s5, s4, 8
    s_and_b32 s5, s5, 8192
    s_xor_b32 s4, s4, s5
    s_add_u32 s38, s42, s4
    s_addc_u32 s39, s43, 0
    v_and_b32_dpp v60, v54, v8 row_newbcast:4 row_mask:0xf bank_mask:0xf
    v_and_b32_dpp v61, v54, v9 row_newbcast:4 row_mask:0xf bank_mask:0xf
    v_and_b32_dpp v62, v54, v10 row_newbcast:4 row_mask:0xf bank_mask:0xf
    v_and_b32_dpp v63, v54, v11 row_newbcast:4 row_mask:0xf bank_mask:0xf
    s_waitcnt vmcnt(7)
    v_mfma_f32_16x16x32_bf16 v[16:19], v[160:163], v[56:59], v[16:19]
    global_load_dwordx4 v[128:131], v36, s[38:39] offset:0 nt
    s_cmp_eq_u32 s11, 1
    s_cbranch_scc0 L_xax
    s_or_b32 s13, s90, 0x100
    s_atomic_add s13, s[22:23], 0
    s_mov_b32 s11, 2
L_xax:
    v_and_b32_dpp v56, v54, v8 row_newbcast:8 row_mask:0xf bank_mask:0xf
    v_and_b32_dpp v57, v54, v9 row_newbcast:8 row_mask:0xf bank_mask:0xf
    v_and_b32_dpp v58, v54, v10 row_newbcast:8 row_mask:0xf bank_mask:0xf
    v_and_b32_dpp v59, v54, v11 row_newbcast:8 row_mask:0xf bank_mask:0xf
    s_waitcnt vmcnt(7)
    v_mfma_f32_16x16x32_bf16 v[16:19], v[164:167], v[60:63], v[16:19]
    global_load_dwordx4 v[132:135], v37, s[38:39] offset:0 nt
    v_and_b32_dpp v60, v54, v8 row_newbcast:12 row_mask:0xf bank_mask:0xf
    v_and_b32_dpp v61, v54, v9 row_newbcast:12 row_mask:0xf bank_mask:0xf
    v_and_b32_dpp v62, v54, v10 row_newbcast:12 row_mask:0xf bank_mask:0xf
    v_and_b32_dpp v63, v54, v11 row_newbcast:12 row_mask:0xf bank_mask:0xf
    s_waitcnt vmcnt(7)
    v_mfma_f32_16x16x32_bf16 v[16:19], v[168:171], v[56:59], v[16:19]
    global_load_dwordx4 v[136:139], v38, s[38:39] offset:0 nt
    v_and_b32_dpp v56, v55, v8 row_newbcast:0 row_mask:0xf bank_mask:0xf
    v_and_b32_dpp v57, v55, v9 row_newbcast:0 row_mask:0xf bank_mask:0xf
    v_and_b32_dpp v58, v55, v10 row_newbcast:0 row_mask:0xf bank_mask:0xf
    v_and_b32_dpp v59, v55, v11 row_newbcast:0 row_mask:0xf bank_mask:0xf
    s_waitcnt vmcnt(7)
    v_mfma_f32_16x16x32_bf16 v[16:19], v[172:175], v[60:63], v[16:19]
    global_load_dwordx4 v[140:143], v39, s[38:39] offset:0 nt
    v_and_b32_dpp v60, v55, v8 row_newbcast:4 row_mask:0xf bank_mask:0xf
    v_and_b32_dpp v61, v55, v9 row_newbcast:4 row_mask:0xf bank_mask:0xf
    v_and_b32_dpp v62, v55, v10 row_newbcast:4 row_mask:0xf bank_mask:0xf
    v_and_b32_dpp v63, v55, v11 row_newbcast:4 row_mask:0xf bank_mask:0xf
    s_waitcnt vmcnt(7)
    v_mfma_f32_16x16x32_bf16 v[16:19], v[176:179], v[56:59], v[16:19]
    global_load_dwordx4 v[144:147], v36, s[38:39] offset:1024 nt
    v_and_b32_dpp v56, v55, v8 row_newbcast:8 row_mask:0xf bank_mask:0xf
    v_and_b32_dpp v57, v55, v9 row_newbcast:8 row_mask:0xf bank_mask:0xf
    v_and_b32_dpp v58, v55, v10 row_newbcast:8 row_mask:0xf bank_mask:0xf
    v_and_b32_dpp v59, v55, v11 row_newbcast:8 row_mask:0xf bank_mask:0xf
    s_waitcnt vmcnt(7)
    v_mfma_f32_16x16x32_bf16 v[16:19], v[180:183], v[60:63], v[16:19]
    global_load_dwordx4 v[148:151], v37, s[38:39] offset:1024 nt
    v_and_b32_dpp v60, v55, v8 row_newbcast:12 row_mask:0xf bank_mask:0xf
    v_and_b32_dpp v61, v55, v9 row_newbcast:12 row_mask:0xf bank_mask:0xf
    v_and_b32_dpp v62, v55, v10 row_newbcast:12 row_mask:0xf bank_mask:0xf
    v_and_b32_dpp v63, v55, v11 row_newbcast:12 row_mask:0xf bank_mask:0xf
    s_waitcnt vmcnt(7)
    v_mfma_f32_16x16x32_bf16 v[16:19], v[184:187], v[56:59], v[16:19]
    global_load_dwordx4 v[152:155], v38, s[38:39] offset:1024 nt
    s_waitcnt vmcnt(7)
    v_mfma_f32_16x16x32_bf16 v[16:19], v[188:191], v[60:63], v[16:19]
    global_load_dwordx4 v[156:159], v39, s[38:39] offset:1024 nt
    s_branch L_vctl
L_resc_x:
    v_max_f32_dpp v68, v68, v68 row_ror:8 row_mask:0xf bank_mask:0xf
    s_nop 1
    v_max_f32_dpp v68, v68, v68 row_ror:4 row_mask:0xf bank_mask:0xf
    s_nop 1
    v_max_f32_dpp v68, v68, v68 row_bcast:15 row_mask:0xa bank_mask:0xf
    s_nop 1
    v_max_f32_dpp v68, v68, v68 row_bcast:31 row_mask:0xc bank_mask:0xf
    s_nop 0
    v_readlane_b32 s67, v68, 63
    s_nop 1
    v_max_f32 v69, s67, v12
    v_sub_f32 v68, v12, v69
    v_exp_f32 v68, v68
    v_mov_b32 v12, v69
    v_mul_f32 v16, v16, v68
    v_mul_f32 v17, v17, v68
    v_mul_f32 v18, v18, v68
    v_mul_f32 v19, v19, v68
    v_mul_f32 v13, v13, v68
    s_branch L_cont_x
L_vslow_x:
    s_mov_b32 s52, 262144
L_spin_6:
    global_load_dwordx2 v[48:49], v50, s[94:95] sc1
    s_waitcnt vmcnt(0)
    v_max_u32 v1, v48, v49
    v_cmp_eq_u32 vcc, -1, v1
    s_cbranch_vccz L_spindone_7
    s_sub_u32 s52, s52, 1
    s_cmp_lg_u32 s52, 0
    s_cbranch_scc1 L_spin_6
L_spindone_7:
    s_branch L_vq_x
L_fin_x:
    s_branch L_fin_a
L_resc_a:
    v_max_f32_dpp v68, v68, v68 row_ror:8 row_mask:0xf bank_mask:0xf
    s_nop 1
    v_max_f32_dpp v68, v68, v68 row_ror:4 row_mask:0xf bank_mask:0xf
    s_nop 1
    v_max_f32_dpp v68, v68, v68 row_bcast:15 row_mask:0xa bank_mask:0xf
    s_nop 1
    v_max_f32_dpp v68, v68, v68 row_bcast:31 row_mask:0xc bank_mask:0xf
    s_nop 0
    v_readlane_b32 s67, v68, 63
    s_nop 1
    v_max_f32 v69, s67, v12
    v_sub_f32 v68, v12, v69
    v_exp_f32 v68, v68
    v_mov_b32 v12, v69
    v_mul_f32 v16, v16, v68
    v_mul_f32 v17, v17, v68
    v_mul_f32 v18, v18, v68
    v_mul_f32 v19, v19, v68
    v_mul_f32 v13, v13, v68
    s_branch L_cont_a
L_resc_b:
    v_max_f32_dpp v68, v68, v68 row_ror:8 row_mask:0xf bank_mask:0xf
    s_nop 1
    v_max_f32_dpp v68, v68, v68 row_ror:4 row_mask:0xf bank_mask:0xf
    s_nop 1
    v_max_f32_dpp v68, v68, v68 row_bcast:15 row_mask:0xa bank_mask:0xf
    s_nop 1
    v_max_f32_dpp v68, v68, v68 row_bcast:31 row_mask:0xc bank_mask:0xf
    s_nop 0
    v_readlane_b32 s67, v68, 63
    s_nop 1
    v_max_f32 v69, s67, v12
    v_sub_f32 v68, v12, v69
    v_exp_f32 v68, v68
    v_mov_b32 v12, v69
    v_mul_f32 v16, v16, v68
    v_mul_f32 v17, v17, v68
    v_mul_f32 v18, v18, v68
    v_mul_f32 v19, v19, v68
    v_mul_f32 v13, v13, v68
    s_branch L_cont_b
L_vslow_a:
    s_mov_b32 s52, 262144
L_spin_8:
    global_load_dwordx2 v[48:49], v50, s[94:95] sc1
    s_waitcnt vmcnt(0)
    v_max_u32 v1, v48, v49
    v_cmp_eq_u32 vcc, -1, v1
    s_cbranch_vccz L_spindone_9
    s_sub_u32 s52, s52, 1
    s_cmp_lg_u32 s52, 0
    s_cbranch_scc1 L_spin_8
L_spindone_9:
    s_branch L_vq_a
L_vslow_b:
    s_mov_b32 s52, 262144
L_spin_10:
    global_load_dwordx2 v[48:49], v50, s[94:95] sc1
    s_waitcnt vmcnt(0)
    v_max_u32 v1, v48, v49
    v_cmp_eq_u32 vcc, -1, v1
    s_cbranch_vccz L_spindone_11
    s_sub_u32 s52, s52, 1
    s_cmp_lg_u32 s52, 0
    s_cbranch_scc1 L_spin_10
L_spindone_11:
    s_branch L_vq_b
L_fin_b:
    v_add_f32_dpp v13, v13, v13 row_ror:8 row_mask:0xf bank_mask:0xf
    s_nop 1
    v_add_f32_dpp v13, v13, v13 row_ror:4 row_mask:0xf bank_mask:0xf
    s_nop 1
    v_add_f32_dpp v13, v13, v13 row_ror:2 row_mask:0xf bank_mask:0xf
    s_nop 1
    v_add_f32_dpp v13, v13, v13 row_ror:1 row_mask:0xf bank_mask:0xf
    s_nop 1
    v_add_f32_dpp v13, v13, v13 row_bcast:15 row_mask:0xa bank_mask:0xf
    s_nop 1
    v_add_f32_dpp v13, v13, v13 row_bcast:31 row_mask:0xc bank_mask:0xf
    s_nop 0
    v_readlane_b32 s67, v13, 63
    v_mov_b32 v2, 0x3e800000
    s_nop 0
    v_mul_f32 v13, s67, v2
    s_mul_i32 s7, s97, 0
    s_lshl_b32 s4, s70, 3
    s_add_u32 s4, s4, s7
    v_mov_b32 v2, s4
    ds_write_b64 v2, v[12:13] offset:6656
    v_lshrrev_b32 v1, 4, v0
    v_and_b32 v2, 7, v0
    v_lshl_add_u32 v1, v1, 3, v2
    s_lshl_b32 s4, s64, 2
    s_add_u32 s4, s4, s93
    s_lshl_b32 s4, s4, 10
    s_add_u32 s4, s4, 335872
    v_lshl_add_u32 v50, v1, 4, s4
    v_mov_b32 v51, s4
    s_lshl_b32 s4, s70, 10
    s_add_u32 s4, s4, s7
    v_lshl_add_u32 v3, v0, 4, s4
    v_mov_b32 v2, 0
    v_lshlrev_b32 v1, 4, v0
    v_and_b32_dpp v60, v54, v8 row_newbcast:4 row_mask:0xf bank_mask:0xf
    v_and_b32_dpp v61, v54, v9 row_newbcast:4 row_mask:0xf bank_mask:0xf
    v_and_b32_dpp v62, v54, v10 row_newbcast:4 row_mask:0xf bank_mask:0xf
    v_and_b32_dpp v63, v54, v11 row_newbcast:4 row_mask:0xf bank_mask:0xf
    s_waitcnt vmcnt(7)
    v_mfma_f32_16x16x32_bf16 v[16:19], v[160:163], v[56:59], v[16:19]
    v_and_b32_dpp v56, v54, v8 row_newbcast:8 row_mask:0xf bank_mask:0xf
    v_and_b32_dpp v57, v54, v9 row_newbcast:8 row_mask:0xf bank_mask:0xf
    v_and_b32_dpp v58, v54, v10 row_newbcast:8 row_mask:0xf bank_mask:0xf
    v_and_b32_dpp v59, v54, v11 row_newbcast:8 row_mask:0xf bank_mask:0xf
    s_waitcnt vmcnt(6)
    v_mfma_f32_16x16x32_bf16 v[16:19], v[164:167], v[60:63], v[16:19]
    v_and_b32_dpp v60, v54, v8 row_newbcast:12 row_mask:0xf bank_mask:0xf
    v_and_b32_dpp v61, v54, v9 row_newbcast:12 row_mask:0xf bank_mask:0xf
    v_and_b32_dpp v62, v54, v10 row_newbcast:12 row_mask:0xf bank_mask:0xf
    v_and_b32_dpp v63, v54, v11 row_newbcast:12 row_mask:0xf bank_mask:0xf
    s_waitcnt vmcnt(5)
    v_mfma_f32_16x16x32_bf16 v[16:19], v[168:171], v[56:59], v[16:19]
    v_and_b32_dpp v56, v55, v8 row_newbcast:0 row_mask:0xf bank_mask:0xf
    v_and_b32_dpp v57, v55, v9 row_newbcast:0 row_mask:0xf bank_mask:0xf
    v_and_b32_dpp v58, v55, v10 row_newbcast:0 row_mask:0xf bank_mask:0xf
    v_and_b32_dpp v59, v55, v11 row_newbcast:0 row_mask:0xf bank_mask:0xf
    s_waitcnt vmcnt(4)
    v_mfma_f32_16x16x32_bf16 v[16:19], v[172:175], v[60:63], v[16:19]
    v_and_b32_dpp v60, v55, v8 row_newbcast:4 row_mask:0xf bank_mask:0xf
    v_and_b32_dpp v61, v55, v9 row_newbcast:4 row_mask:0xf bank_mask:0xf
    v_and_b32_dpp v62, v55, v10 row_newbcast:4 row_mask:0xf bank_mask:0xf
    v_and_b32_dpp v63, v55, v11 row_newbcast:4 row_mask:0xf bank_mask:0xf
    s_waitcnt vmcnt(3)
    v_mfma_f32_16x16x32_bf16 v[16:19], v[176:179], v[56:59], v[16:19]
    v_and_b32_dpp v56, v55, v8 row_newbcast:8 row_mask:0xf bank_mask:0xf
    v_and_b32_dpp v57, v55, v9 row_newbcast:8 row_mask:0xf bank_mask:0xf
    v_and_b32_dpp v58, v55, v10 row_newbcast:8 row_mask:0xf bank_mask:0xf
    v_and_b32_dpp v59, v55, v11 row_newbcast:8 row_mask:0xf bank_mask:0xf
    s_waitcnt vmcnt(2)
    v_mfma_f32_16x16x32_bf16 v[16:19], v[180:183], v[60:63], v[16:19]
    v_and_b32_dpp v60, v55, v8 row_newbcast:12 row_mask:0xf bank_mask:0xf
    v_and_b32_dpp v61, v55, v9 row_newbcast:12 row_mask:0xf bank_mask:0xf
    v_and_b32_dpp v62, v55, v10 row_newbcast:12 row_mask:0xf bank_mask:0xf
    v_and_b32_dpp v63, v55, v11 row_newbcast:12 row_mask:0xf bank_mask:0xf
    s_waitcnt vmcnt(1)
    v_mfma_f32_16x16x32_bf16 v[16:19], v[184:187], v[56:59], v[16:19]
    s_waitcnt vmcnt(0)
    v_mfma_f32_16x16x32_bf16 v[16:19], v[188:191], v[60:63], v[16:19]
    s_branch L_e1
L_fin_a:
    v_add_f32_dpp v13, v13, v13 row_ror:8 row_mask:0xf bank_mask:0xf
    s_nop 1
    v_add_f32_dpp v13, v13, v13 row_ror:4 row_mask:0xf bank_mask:0xf
    s_nop 1
    v_add_f32_dpp v13, v13, v13 row_ror:2 row_mask:0xf bank_mask:0xf
    s_nop 1
    v_add_f32_dpp v13, v13, v13 row_ror:1 row_mask:0xf bank_mask:0xf
    s_nop 1
    v_add_f32_dpp v13, v13, v13 row_bcast:15 row_mask:0xa bank_mask:0xf
    s_nop 1
    v_add_f32_dpp v13, v13, v13 row_bcast:31 row_mask:0xc bank_mask:0xf
    s_nop 0
    v_readlane_b32 s67, v13, 63
    v_mov_b32 v2, 0x3e800000
    s_nop 0
    v_mul_f32 v13, s67, v2
    s_mul_i32 s7, s97, 0
    s_lshl_b32 s4, s70, 3
    s_add_u32 s4, s4, s7
    v_mov_b32 v2, s4
    ds_write_b64 v2, v[12:13] offset:6656
    v_lshrrev_b32 v1, 4, v0
    v_and_b32 v2, 7, v0
    v_lshl_add_u32 v1, v1, 3, v2
    s_lshl_b32 s4, s64, 2
    s_add_u32 s4, s4, s93
    s_lshl_b32 s4, s4, 10
    s_add_u32 s4, s4, 335872
    v_lshl_add_u32 v50, v1, 4, s4
    v_mov_b32 v51, s4
    s_lshl_b32 s4, s70, 10
    s_add_u32 s4, s4, s7
    v_lshl_add_u32 v3, v0, 4, s4
    v_mov_b32 v2, 0
    v_lshlrev_b32 v1, 4, v0
    v_and_b32_dpp v60, v54, v8 row_newbcast:4 row_mask:0xf bank_mask:0xf
    v_and_b32_dpp v61, v54, v9 row_newbcast:4 row_mask:0xf bank_mask:0xf
    v_and_b32_dpp v62, v54, v10 row_newbcast:4 row_mask:0xf bank_mask:0xf
    v_and_b32_dpp v63, v54, v11 row_newbcast:4 row_mask:0xf bank_mask:0xf
    s_waitcnt vmcnt(7)
    v_mfma_f32_16x16x32_bf16 v[16:19], v[160:163], v[56:59], v[16:19]
    v_and_b32_dpp v56, v54, v8 row_newbcast:8 row_mask:0xf bank_mask:0xf
    v_and_b32_dpp v57, v54, v9 row_newbcast:8 row_mask:0xf bank_mask:0xf
    v_and_b32_dpp v58, v54, v10 row_newbcast:8 row_mask:0xf bank_mask:0xf
    v_and_b32_dpp v59, v54, v11 row_newbcast:8 row_mask:0xf bank_mask:0xf
    s_waitcnt vmcnt(6)
    v_mfma_f32_16x16x32_bf16 v[16:19], v[164:167], v[60:63], v[16:19]
    v_and_b32_dpp v60, v54, v8 row_newbcast:12 row_mask:0xf bank_mask:0xf
    v_and_b32_dpp v61, v54, v9 row_newbcast:12 row_mask:0xf bank_mask:0xf
    v_and_b32_dpp v62, v54, v10 row_newbcast:12 row_mask:0xf bank_mask:0xf
    v_and_b32_dpp v63, v54, v11 row_newbcast:12 row_mask:0xf bank_mask:0xf
    s_waitcnt vmcnt(5)
    v_mfma_f32_16x16x32_bf16 v[16:19], v[168:171], v[56:59], v[16:19]
    v_and_b32_dpp v56, v55, v8 row_newbcast:0 row_mask:0xf bank_mask:0xf
    v_and_b32_dpp v57, v55, v9 row_newbcast:0 row_mask:0xf bank_mask:0xf
    v_and_b32_dpp v58, v55, v10 row_newbcast:0 row_mask:0xf bank_mask:0xf
    v_and_b32_dpp v59, v55, v11 row_newbcast:0 row_mask:0xf bank_mask:0xf
    s_waitcnt vmcnt(4)
    v_mfma_f32_16x16x32_bf16 v[16:19], v[172:175], v[60:63], v[16:19]
    v_and_b32_dpp v60, v55, v8 row_newbcast:4 row_mask:0xf bank_mask:0xf
    v_and_b32_dpp v61, v55, v9 row_newbcast:4 row_mask:0xf bank_mask:0xf
    v_and_b32_dpp v62, v55, v10 row_newbcast:4 row_mask:0xf bank_mask:0xf
    v_and_b32_dpp v63, v55, v11 row_newbcast:4 row_mask:0xf bank_mask:0xf
    s_waitcnt vmcnt(3)
    v_mfma_f32_16x16x32_bf16 v[16:19], v[176:179], v[56:59], v[16:19]
    v_and_b32_dpp v56, v55, v8 row_newbcast:8 row_mask:0xf bank_mask:0xf
    v_and_b32_dpp v57, v55, v9 row_newbcast:8 row_mask:0xf bank_mask:0xf
    v_and_b32_dpp v58, v55, v10 row_newbcast:8 row_mask:0xf bank_mask:0xf
    v_and_b32_dpp v59, v55, v11 row_newbcast:8 row_mask:0xf bank_mask:0xf
    s_waitcnt vmcnt(2)
    v_mfma_f32_16x16x32_bf16 v[16:19], v[180:183], v[60:63], v[16:19]
    v_and_b32_dpp v60, v55, v8 row_newbcast:12 row_mask:0xf bank_mask:0xf
    v_and_b32_dpp v61, v55, v9 row_newbcast:12 row_mask:0xf bank_mask:0xf
    v_and_b32_dpp v62, v55, v10 row_newbcast:12 row_mask:0xf bank_mask:0xf
    v_and_b32_dpp v63, v55, v11 row_newbcast:12 row_mask:0xf bank_mask:0xf
    s_waitcnt vmcnt(1)
    v_mfma_f32_16x16x32_bf16 v[16:19], v[184:187], v[56:59], v[16:19]
    s_waitcnt vmcnt(0)
    v_mfma_f32_16x16x32_bf16 v[16:19], v[188:191], v[60:63], v[16:19]
L_e1:
    s_nop 7
    ds_write_b128 v3, v[16:19] offset:2560
    s_waitcnt lgkmcnt(0)
    s_barrier
    s_cmp_lg_u32 s70, 0
    s_cbranch_scc1 L_fin
L_comb:
    ds_read_b128 v[64:67], v2 offset:6656
    ds_read_b128 v[68:71], v2 offset:6672
    ds_read_b128 v[88:91], v1 offset:2560
    ds_read_b128 v[92:95], v1 offset:3584
    ds_read_b128 v[96:99], v1 offset:4608
    ds_read_b128 v[100:103], v1 offset:5632
    s_waitcnt lgkmcnt(4)
    v_max3_f32 v80, v64, v66, v68
    v_max_f32 v80, v80, v70
    v_sub_f32 v64, v64, v80
    v_sub_f32 v66, v66, v80
    v_sub_f32 v68, v68, v80
    v_sub_f32 v70, v70, v80
    v_exp_f32 v64, v64
    v_exp_f32 v66, v66
    v_exp_f32 v68, v68
    v_exp_f32 v70, v70
    v_mul_f32 v81, v64, v65
    v_fmac_f32 v81, v66, v67
    v_fmac_f32 v81, v68, v69
    v_fmac_f32 v81, v70, v71
    s_waitcnt lgkmcnt(0)
    v_mul_f32 v84, v64, v88
    v_mul_f32 v85, v64, v89
    v_mul_f32 v86, v64, v90
    v_mul_f32 v87, v64, v91
    v_fmac_f32 v84, v66, v92
    v_fmac_f32 v85, v66, v93
    v_fmac_f32 v86, v66, v94
    v_fmac_f32 v87, v66, v95
    v_fmac_f32 v84, v68, v96
    v_fmac_f32 v85, v68, v97
    v_fmac_f32 v86, v68, v98
    v_fmac_f32 v87, v68, v99
    v_fmac_f32 v84, v70, v100
    v_fmac_f32 v85, v70, v101
    v_fmac_f32 v86, v70, v102
    v_fmac_f32 v87, v70, v103
    v_min_u32 v84, -2, v84
    v_min_u32 v85, -2, v85
    v_min_u32 v86, -2, v86
    v_min_u32 v87, -2, v87
    v_min_u32 v80, -2, v80
    v_min_u32 v81, -2, v81
    s_mov_b32 exec_lo, 0x00ff00ff
    s_mov_b32 exec_hi, 0x00ff00ff
    global_store_dwordx4 v50, v[84:87], s[98:99] sc1
    s_mov_b64 exec, 1
    global_store_dwordx2 v51, v[80:81], s[98:99] offset:512 sc1
    s_mov_b64 exec, -1
    s_branch L_fin
L_helper:
    v_mov_b32 v64, -1
    v_mov_b32 v65, -1
    v_mov_b32 v66, -1
    v_mov_b32 v67, -1
    v_mov_b32 v1, 11072
    v_mov_b32 v4, 0
    v_mov_b32 v5, 0
    v_mov_b32 v6, 0
    v_mov_b32 v7, 0
    ds_write_b128 v1, v[4:7]
    ds_write_b128 v1, v[4:7] offset:16
    s_waitcnt lgkmcnt(0)
    s_mov_b32 s97, 0
    s_add_u32 s98, s34, 0
    s_addc_u32 s99, s35, 0
    s_cmp_lt_u32 s96, 1
    s_cbranch_scc1 L_Z
    s_cmp_lt_u32 s96, 17
    s_cbranch_scc1 L_P1a
    s_cmp_lt_u32 s96, 33
    s_cbranch_scc1 L_Y
    s_cmp_lt_u32 s96, 40
    s_cbranch_scc1 L_N
    s_cmp_lt_u32 s96, 64
    s_cbranch_scc1 L_P1b
    s_cmp_lt_u32 s96, 128
    s_cbranch_scc1 L_P2
    s_cmp_lt_u32 s96, 192
    s_cbranch_scc1 L_W0
    s_cmp_lt_u32 s96, 248
    s_cbranch_scc1 L_M0
    s_sub_u32 s96, s96, 184
    s_branch L_P1b
L_N:
    s_barrier
    s_branch L_plain
L_Z:
    s_cmp_lg_u32 s70, 0
    s_cbranch_scc1 L_Z1
    v_lshlrev_b32 v1, 4, v0
    global_store_dwordx4 v1, v[64:67], s[34:35] offset:0 sc1
    global_store_dwordx4 v1, v[64:67], s[34:35] offset:1024 sc1
    global_store_dwordx4 v1, v[64:67], s[34:35] offset:2048 sc1
    global_store_dwordx4 v1, v[64:67], s[34:35] offset:3072 sc1
    s_barrier
    s_waitcnt vmcnt(0)
    v_mov_b32 v2, 1
    s_mov_b64 exec, 1
    global_store_dword v4, v2, s[32:33] sc1
    s_mov_b64 exec, -1
    v_mov_b32 v1, 11072
    v_mov_b32 v2, 1
    s_waitcnt lgkmcnt(0)
    s_mov_b64 exec, 1
    ds_add_u32 v1, v2
    s_mov_b64 exec, -1
    s_branch L_qwait0
L_Z1:
    s_cmp_lg_u32 s70, 1
    s_cbranch_scc1 L_Z2
    v_lshlrev_b32 v3, 7, v0
    v_add_u32 v3, 36864, v3
    v_add_u32 v2, 8192, v3
    global_store_dwordx4 v3, v[4:7], s[34:35] offset:-4096 sc1
    global_store_dwordx4 v2, v[4:7], s[34:35] offset:-4096 sc1
    v_lshlrev_b32 v1, 4, v0
    v_add_u32 v1, 53248, v1
    global_store_dwordx4 v1, v[4:7], s[34:35] offset:0 sc1
    global_store_dwordx4 v1, v[4:7], s[34:35] offset:1024 sc1
    global_store_dwordx4 v1, v[4:7], s[34:35] offset:2048 sc1
    global_store_dwordx4 v1, v[4:7], s[34:35] offset:3072 sc1
    v_and_b32 v3, 15, v0
    v_lshlrev_b32 v3, 7, v3
    v_add_u32 v3, 49152, v3
    global_store_dword v3, v4, s[34:35] sc1
    v_lshlrev_b32 v3, 7, v0
    v_add_u32 v3, 57344, v3
    global_store_dword v3, v4, s[34:35] sc1
    s_branch L_Z3
L_Z2:
    s_sub_u32 s4, s70, 2
    s_lshl_b32 s4, s4, 13
    s_add_u32 s4, s4, 20480
    v_lshl_add_u32 v2, v0, 4, s4
    global_store_dwordx4 v2, v[64:67], s[34:35] offset:-4096 sc1
    global_store_dwordx4 v2, v[64:67], s[34:35] offset:-3072 sc1
    global_store_dwordx4 v2, v[64:67], s[34:35] offset:-2048 sc1
    global_store_dwordx4 v2, v[64:67], s[34:35] offset:-1024 sc1
    global_store_dwordx4 v2, v[64:67], s[34:35] offset:0 sc1
    global_store_dwordx4 v2, v[64:67], s[34:35] offset:1024 sc1
    global_store_dwordx4 v2, v[64:67], s[34:35] offset:2048 sc1
    global_store_dwordx4 v2, v[64:67], s[34:35] offset:3072 sc1
L_Z3:
    s_barrier
    s_waitcnt vmcnt(0)
    v_mov_b32 v1, 11072
    v_mov_b32 v2, 1
    s_waitcnt lgkmcnt(0)
    s_mov_b64 exec, 1
    ds_add_u32 v1, v2
    s_mov_b64 exec, -1
    s_cmp_lg_u32 s70, 1
    s_cbranch_scc1 L_hexit2
    v_mov_b32 v1, 11072
L_lw_12:
    ds_read_b32 v2, v1
    s_waitcnt lgkmcnt(0)
    v_cmp_gt_u32 vcc, 4, v2
    s_cbranch_vccnz L_lw_12
    v_mov_b32 v2, 1
    s_mov_b64 exec, 1
    global_store_dword v4, v2, s[32:33] offset:4 sc1
    s_mov_b64 exec, -1
L_hexit2:
    s_branch L_hexit
L_Y:
    s_sub_u32 s48, s96, 17
    s_lshl_b32 s4, s48, 2
    s_add_u32 s4, s4, s70
    s_mul_i32 s4, s4, 17408
    s_add_u32 s4, s4, 69632
    v_lshl_add_u32 v1, v0, 4, s4
    global_store_dwordx4 v1, v[64:67], s[34:35] offset:-4096 sc1
    global_store_dwordx4 v1, v[64:67], s[34:35] offset:-3072 sc1
    global_store_dwordx4 v1, v[64:67], s[34:35] offset:-2048 sc1
    global_store_dwordx4 v1, v[64:67], s[34:35] offset:-1024 sc1
    global_store_dwordx4 v1, v[64:67], s[34:35] offset:0 sc1
    global_store_dwordx4 v1, v[64:67], s[34:35] offset:1024 sc1
    global_store_dwordx4 v1, v[64:67], s[34:35] offset:2048 sc1
    global_store_dwordx4 v1, v[64:67], s[34:35] offset:3072 sc1
    v_add_u32 v1, 8192, v1
    global_store_dwordx4 v1, v[64:67], s[34:35] offset:-4096 sc1
    global_store_dwordx4 v1, v[64:67], s[34:35] offset:-3072 sc1
    global_store_dwordx4 v1, v[64:67], s[34:35] offset:-2048 sc1
    global_store_dwordx4 v1, v[64:67], s[34:35] offset:-1024 sc1
    global_store_dwordx4 v1, v[64:67], s[34:35] offset:0 sc1
    global_store_dwordx4 v1, v[64:67], s[34:35] offset:1024 sc1
    global_store_dwordx4 v1, v[64:67], s[34:35] offset:2048 sc1
    global_store_dwordx4 v1, v[64:67], s[34:35] offset:3072 sc1
    v_add_u32 v1, 8192, v1
    global_store_dwordx4 v1, v[64:67], s[34:35] offset:-4096 sc1
    s_barrier
    s_waitcnt vmcnt(0)
    v_mov_b32 v1, 11072
    v_mov_b32 v2, 1
    s_waitcnt lgkmcnt(0)
    s_mov_b64 exec, 1
    ds_add_u32 v1, v2
    s_mov_b64 exec, -1
    s_cmp_lg_u32 s70, 0
    s_cbranch_scc1 L_hexit
    v_mov_b32 v1, 11072
L_lw_13:
    ds_read_b32 v2, v1
    s_waitcnt lgkmcnt(0)
    v_cmp_gt_u32 vcc, 4, v2
    s_cbranch_vccnz L_lw_13
    v_mov_b32 v1, s48
    v_mov_b32 v2, 1
    s_mov_b64 exec, 1
    global_store_byte v1, v2, s[32:33] offset:128 sc1
    s_mov_b64 exec, -1
    s_branch L_qwait0
L_P1a:
    s_sub_u32 s48, s96, 1
    s_lshl_b32 s4, s70, 9
    v_lshl_add_u32 v69, v0, 3, s4
    global_load_dwordx2 v[70:71], v69, s[26:27]
    s_lshl_b32 s6, s48, 7
    v_lshrrev_b32 v3, 3, v0
    v_mov_b32 v1, v3
    v_mul_u32_u24 v1, 6144, v1
    v_and_b32 v3, 2, v3
    v_and_b32 v2, 7, v0
    v_xor_b32 v2, v2, v3
    v_lshlrev_b32 v2, 4, v2
    v_add_u32 v1, v1, v2
    v_xor_b32 v2, 64, v1
    s_mul_i32 s4, s70, 786432
    s_add_u32 s4, s4, s6
    s_add_u32 s50, s28, s4
    s_addc_u32 s51, s29, 0
    s_lshl_b32 s5, s70, 14
    s_add_u32 m0, s5, 16384
    s_nop 0
    global_load_lds_dwordx4 v1, s[50:51] nt
    s_add_u32 s50, s50, 49152
    s_addc_u32 s51, s51, 0
    s_add_u32 m0, s5, 17408
    s_nop 0
    global_load_lds_dwordx4 v2, s[50:51] nt
    s_add_u32 s50, s50, 49152
    s_addc_u32 s51, s51, 0
    s_add_u32 m0, s5, 18432
    s_nop 0
    global_load_lds_dwordx4 v1, s[50:51] nt
    s_add_u32 s50, s50, 49152
    s_addc_u32 s51, s51, 0
    s_add_u32 m0, s5, 19456
    s_nop 0
    global_load_lds_dwordx4 v2, s[50:51] nt
    s_add_u32 s50, s50, 49152
    s_addc_u32 s51, s51, 0
    s_add_u32 m0, s5, 20480
    s_nop 0
    global_load_lds_dwordx4 v1, s[50:51] nt
    s_add_u32 s50, s50, 49152
    s_addc_u32 s51, s51, 0
    s_add_u32 m0, s5, 21504
    s_nop 0
    global_load_lds_dwordx4 v2, s[50:51] nt
    s_add_u32 s50, s50, 49152
    s_addc_u32 s51, s51, 0
    s_add_u32 m0, s5, 22528
    s_nop 0
    global_load_lds_dwordx4 v1, s[50:51] nt
    s_add_u32 s50, s50, 49152
    s_addc_u32 s51, s51, 0
    s_add_u32 m0, s5, 23552
    s_nop 0
    global_load_lds_dwordx4 v2, s[50:51] nt
    s_add_u32 s50, s50, 49152
    s_addc_u32 s51, s51, 0
    s_add_u32 m0, s5, 24576
    s_nop 0
    global_load_lds_dwordx4 v1, s[50:51] nt
    s_add_u32 s50, s50, 49152
    s_addc_u32 s51, s51, 0
    s_add_u32 m0, s5, 25600
    s_nop 0
    global_load_lds_dwordx4 v2, s[50:51] nt
    s_add_u32 s50, s50, 49152
    s_addc_u32 s51, s51, 0
    s_add_u32 m0, s5, 26624
    s_nop 0
    global_load_lds_dwordx4 v1, s[50:51] nt
    s_add_u32 s50, s50, 49152
    s_addc_u32 s51, s51, 0
    s_add_u32 m0, s5, 27648
    s_nop 0
    global_load_lds_dwordx4 v2, s[50:51] nt
    s_add_u32 s50, s50, 49152
    s_addc_u32 s51, s51, 0
    s_add_u32 m0, s5, 28672
    s_nop 0
    global_load_lds_dwordx4 v1, s[50:51] nt
    s_add_u32 s50, s50, 49152
    s_addc_u32 s51, s51, 0
    s_add_u32 m0, s5, 29696
    s_nop 0
    global_load_lds_dwordx4 v2, s[50:51] nt
    s_add_u32 s50, s50, 49152
    s_addc_u32 s51, s51, 0
    s_add_u32 m0, s5, 30720
    s_nop 0
    global_load_lds_dwordx4 v1, s[50:51] nt
    s_add_u32 s50, s50, 49152
    s_addc_u32 s51, s51, 0
    s_add_u32 m0, s5, 31744
    s_nop 0
    global_load_lds_dwordx4 v2, s[50:51] nt
    s_barrier
    v_lshrrev_b32 v1, 4, v0
    v_bfe_u32 v2, v0, 2, 2
    v_lshl_add_u32 v3, v1, 3, v2
    v_lshlrev_b32 v8, 7, v3
    v_lshrrev_b32 v2, 1, v2
    v_and_b32 v3, 1, v1
    v_lshl_add_u32 v2, v3, 1, v2
    v_xor_b32 v2, s70, v2
    v_lshl_add_u32 v8, v2, 5, v8
    v_and_b32 v2, 3, v0
    v_lshl_add_u32 v8, v2, 3, v8
    v_add_u32 v8, 16384, v8
    v_and_b32 v2, 1, v0
    v_mul_u32_u24 v2, 1088, v2
    v_lshl_add_u32 v9, v1, 4, v2
    v_add_u32 v9, 0, v9
    v_and_b32 v1, 1, v0
    v_lshlrev_b32 v1, 5, v1
    v_lshrrev_b32 v2, 4, v0
    v_lshl_add_u32 v1, v2, 3, v1
    s_lshl_b32 s4, s48, 8
    s_lshl_b32 s5, s70, 6
    s_add_u32 s4, s4, s5
    s_add_u32 s4, s4, 0
    v_add_u32 v10, s4, v1
    s_waitcnt vmcnt(16)
    v_lshlrev_b32 v72, 16, v70
    v_and_b32 v73, s55, v70
    v_lshlrev_b32 v74, 16, v71
    v_and_b32 v75, s55, v71
    v_mul_f32 v76, s53, v72
    v_mul_f32 v77, s53, v73
    v_mul_f32 v78, s53, v74
    v_mul_f32 v79, s53, v75
    v_exp_f32 v76, -v76
    v_exp_f32 v77, -v77
    v_exp_f32 v78, -v78
    v_exp_f32 v79, -v79
    v_add_f32 v76, 1.0, v76
    v_add_f32 v77, 1.0, v77
    v_add_f32 v78, 1.0, v78
    v_add_f32 v79, 1.0, v79
    v_rcp_f32 v76, v76
    v_rcp_f32 v77, v77
    v_rcp_f32 v78, v78
    v_rcp_f32 v79, v79
    v_mul_f32 v72, v72, v76
    v_mul_f32 v73, v73, v77
    v_mul_f32 v74, v74, v78
    v_mul_f32 v75, v75, v79
    v_cvt_pk_bf16_f32 v72, v72, v73
    v_cvt_pk_bf16_f32 v73, v74, v75
    s_lshr_b32 s4, s70, 1
    s_mul_i32 s4, s4, 64
    s_add_u32 s4, s4, 0
    v_add_u32 v69, s4, v69
    ds_write_b64 v69, v[72:73]
    s_cmp_lg_u32 s70, 0
    s_cbranch_scc1 L_P1a_w
    v_mov_b32 v3, 0
    s_mov_b32 s52, 262144
L_spin_14:
    global_load_dword v2, v3, s[32:33] sc1
    s_waitcnt vmcnt(0)
    v_cmp_eq_u32 vcc, 0, v2
    s_cbranch_vccz L_spindone_15
    s_sub_u32 s52, s52, 1
    s_cmp_lg_u32 s52, 0
    s_cbranch_scc1 L_spin_14
L_spindone_15:
L_P1a_w:
    s_waitcnt vmcnt(0)
    v_mov_b32 v1, 11072
    v_mov_b32 v2, 1
    s_waitcnt lgkmcnt(0)
    s_mov_b64 exec, 1
    ds_add_u32 v1, v2
    s_mov_b64 exec, -1
    v_mov_b32 v1, 11072
L_lw_16:
    ds_read_b32 v2, v1
    s_waitcnt lgkmcnt(0)
    v_cmp_gt_u32 vcc, 4, v2
    s_cbranch_vccnz L_lw_16
    ds_read_b64_tr_b16 v[128:129], v8 offset:0
    ds_read_b64_tr_b16 v[130:131], v8 offset:512
    ds_read_b64_tr_b16 v[132:133], v8 offset:4096
    ds_read_b64_tr_b16 v[134:135], v8 offset:4608
    ds_read_b64_tr_b16 v[136:137], v8 offset:8192
    ds_read_b64_tr_b16 v[138:139], v8 offset:8704
    ds_read_b64_tr_b16 v[140:141], v8 offset:12288
    ds_read_b64_tr_b16 v[142:143], v8 offset:12800
    ds_read_b64_tr_b16 v[144:145], v8 offset:16384
    ds_read_b64_tr_b16 v[146:147], v8 offset:16896
    ds_read_b64_tr_b16 v[148:149], v8 offset:20480
    ds_read_b64_tr_b16 v[150:151], v8 offset:20992
    ds_read_b64_tr_b16 v[152:153], v8 offset:24576
    ds_read_b64_tr_b16 v[154:155], v8 offset:25088
    ds_read_b64_tr_b16 v[156:157], v8 offset:28672
    ds_read_b64_tr_b16 v[158:159], v8 offset:29184
    ds_read_b64_tr_b16 v[160:161], v8 offset:32768
    ds_read_b64_tr_b16 v[162:163], v8 offset:33280
    ds_read_b64_tr_b16 v[164:165], v8 offset:36864
    ds_read_b64_tr_b16 v[166:167], v8 offset:37376
    ds_read_b64_tr_b16 v[168:169], v8 offset:40960
    ds_read_b64_tr_b16 v[170:171], v8 offset:41472
    ds_read_b64_tr_b16 v[172:173], v8 offset:45056
    ds_read_b64_tr_b16 v[174:175], v8 offset:45568
    ds_read_b64_tr_b16 v[176:177], v8 offset:49152
    ds_read_b64_tr_b16 v[178:179], v8 offset:49664
    ds_read_b64_tr_b16 v[180:181], v8 offset:53248
    ds_read_b64_tr_b16 v[182:183], v8 offset:53760
    ds_read_b64_tr_b16 v[184:185], v8 offset:57344
    ds_read_b64_tr_b16 v[186:187], v8 offset:57856
    ds_read_b64_tr_b16 v[188:189], v8 offset:61440
    ds_read_b64_tr_b16 v[190:191], v8 offset:61952
    ds_read_b128 v[192:195], v9 offset:0
    ds_read_b128 v[196:199], v9 offset:64
    ds_read_b128 v[200:203], v9 offset:128
    ds_read_b128 v[204:207], v9 offset:192
    ds_read_b128 v[208:211], v9 offset:256
    ds_read_b128 v[212:215], v9 offset:320
    ds_read_b128 v[216:219], v9 offset:384
    ds_read_b128 v[220:223], v9 offset:448
    ds_read_b128 v[224:227], v9 offset:512
    ds_read_b128 v[228:231], v9 offset:576
    ds_read_b128 v[232:235], v9 offset:640
    ds_read_b128 v[236:239], v9 offset:704
    ds_read_b128 v[240:243], v9 offset:768
    ds_read_b128 v[244:247], v9 offset:832
    ds_read_b128 v[248:251], v9 offset:896
    ds_read_b128 v[252:255], v9 offset:960
    s_waitcnt lgkmcnt(12)
    v_mfma_f32_16x16x32_bf16 v[16:19], v[128:131], v[192:195], 0
    v_mfma_f32_16x16x32_bf16 v[16:19], v[132:135], v[196:199], v[16:19]
    v_mfma_f32_16x16x32_bf16 v[16:19], v[136:139], v[200:203], v[16:19]
    v_mfma_f32_16x16x32_bf16 v[16:19], v[140:143], v[204:207], v[16:19]
    s_waitcnt lgkmcnt(8)
    v_mfma_f32_16x16x32_bf16 v[16:19], v[144:147], v[208:211], v[16:19]
    v_mfma_f32_16x16x32_bf16 v[16:19], v[148:151], v[212:215], v[16:19]
    v_mfma_f32_16x16x32_bf16 v[16:19], v[152:155], v[216:219], v[16:19]
    v_mfma_f32_16x16x32_bf16 v[16:19], v[156:159], v[220:223], v[16:19]
    s_waitcnt lgkmcnt(4)
    v_mfma_f32_16x16x32_bf16 v[16:19], v[160:163], v[224:227], v[16:19]
    v_mfma_f32_16x16x32_bf16 v[16:19], v[164:167], v[228:231], v[16:19]
    v_mfma_f32_16x16x32_bf16 v[16:19], v[168:171], v[232:235], v[16:19]
    v_mfma_f32_16x16x32_bf16 v[16:19], v[172:175], v[236:239], v[16:19]
    s_waitcnt lgkmcnt(0)
    v_mfma_f32_16x16x32_bf16 v[16:19], v[176:179], v[240:243], v[16:19]
    v_mfma_f32_16x16x32_bf16 v[16:19], v[180:183], v[244:247], v[16:19]
    v_mfma_f32_16x16x32_bf16 v[16:19], v[184:187], v[248:251], v[16:19]
    v_mfma_f32_16x16x32_bf16 v[16:19], v[188:191], v[252:255], v[16:19]
    s_nop 7
    v_cvt_pk_bf16_f32 v16, v16, v17
    v_cvt_pk_bf16_f32 v17, v18, v19
    v_min_u32 v16, -2, v16
    v_min_u32 v17, -2, v17
    s_mov_b32 exec_lo, 0x00030003
    s_mov_b32 exec_hi, 0x00030003
    global_store_dwordx2 v10, v[16:17], s[34:35] sc1
    s_mov_b64 exec, -1
    s_cmp_lg_u32 s70, 0
    s_cbranch_scc1 L_hexit
    s_branch L_qwait0
L_P1b:
    s_sub_u32 s48, s96, 24
    s_lshl_b32 s4, s70, 9
    v_lshl_add_u32 v69, v0, 3, s4
    global_load_dwordx2 v[70:71], v69, s[26:27]
    s_barrier
    s_cmp_lg_u32 s70, 0
    s_cbranch_scc1 L_P1b_gate
    s_mov_b32 s69, 3
    s_cmp_ge_u32 s96, 64
    s_cbranch_scc1 L_vote
    s_branch L_qwait0
L_P1b_gate:
    v_and_b32 v3, 1, v0
    v_lshlrev_b32 v3, 2, v3
    s_mov_b32 s52, 262144
L_spin_17:
    global_load_dword v2, v3, s[32:33] sc1
    s_waitcnt vmcnt(0)
    v_cmp_eq_u32 vcc, 0, v2
    s_cbranch_vccz L_spindone_18
    s_sub_u32 s52, s52, 1
    s_cmp_lg_u32 s52, 0
    s_cbranch_scc1 L_spin_17
L_spindone_18:
L_P1b_go:
    s_lshl_b32 s6, s48, 7
    v_lshrrev_b32 v3, 3, v0
    v_mov_b32 v1, v3
    v_mul_u32_u24 v1, 6144, v1
    v_and_b32 v3, 2, v3
    v_and_b32 v2, 7, v0
    v_xor_b32 v2, v2, v3
    v_lshlrev_b32 v2, 4, v2
    v_add_u32 v1, v1, v2
    v_xor_b32 v2, 64, v1
    s_mul_i32 s4, s70, 786432
    s_add_u32 s4, s4, s6
    s_add_u32 s50, s28, s4
    s_addc_u32 s51, s29, 0
    s_lshl_b32 s5, s70, 14
    s_add_u32 m0, s5, 16384
    s_nop 0
    global_load_lds_dwordx4 v1, s[50:51] nt
    s_add_u32 s50, s50, 49152
    s_addc_u32 s51, s51, 0
    s_add_u32 m0, s5, 17408
    s_nop 0
    global_load_lds_dwordx4 v2, s[50:51] nt
    s_add_u32 s50, s50, 49152
    s_addc_u32 s51, s51, 0
    s_add_u32 m0, s5, 18432
    s_nop 0
    global_load_lds_dwordx4 v1, s[50:51] nt
    s_add_u32 s50, s50, 49152
    s_addc_u32 s51, s51, 0
    s_add_u32 m0, s5, 19456
    s_nop 0
    global_load_lds_dwordx4 v2, s[50:51] nt
    s_add_u32 s50, s50, 49152
    s_addc_u32 s51, s51, 0
    s_add_u32 m0, s5, 20480
    s_nop 0
    global_load_lds_dwordx4 v1, s[50:51] nt
    s_add_u32 s50, s50, 49152
    s_addc_u32 s51, s51, 0
    s_add_u32 m0, s5, 21504
    s_waitcnt vmcnt(4)
    global_load_lds_dwordx4 v2, s[50:51] nt
    s_add_u32 s50, s50, 49152
    s_addc_u32 s51, s51, 0
    s_add_u32 m0, s5, 22528
    s_waitcnt vmcnt(4)
    global_load_lds_dwordx4 v1, s[50:51] nt
    s_add_u32 s50, s50, 49152
    s_addc_u32 s51, s51, 0
    s_add_u32 m0, s5, 23552
    s_waitcnt vmcnt(4)
    global_load_lds_dwordx4 v2, s[50:51] nt
    s_add_u32 s50, s50, 49152
    s_addc_u32 s51, s51, 0
    s_add_u32 m0, s5, 24576
    s_waitcnt vmcnt(4)
    global_load_lds_dwordx4 v1, s[50:51] nt
    s_add_u32 s50, s50, 49152
    s_addc_u32 s51, s51, 0
    s_add_u32 m0, s5, 25600
    s_waitcnt vmcnt(4)
    global_load_lds_dwordx4 v2, s[50:51] nt
    s_add_u32 s50, s50, 49152
    s_addc_u32 s51, s51, 0
    s_add_u32 m0, s5, 26624
    s_waitcnt vmcnt(4)
    global_load_lds_dwordx4 v1, s[50:51] nt
    s_add_u32 s50, s50, 49152
    s_addc_u32 s51, s51, 0
    s_add_u32 m0, s5, 27648
    s_waitcnt vmcnt(4)
    global_load_lds_dwordx4 v2, s[50:51] nt
    s_add_u32 s50, s50, 49152
    s_addc_u32 s51, s51, 0
    s_add_u32 m0, s5, 28672
    s_waitcnt vmcnt(4)
    global_load_lds_dwordx4 v1, s[50:51] nt
    s_add_u32 s50, s50, 49152
    s_addc_u32 s51, s51, 0
    s_add_u32 m0, s5, 29696
    s_waitcnt vmcnt(4)
    global_load_lds_dwordx4 v2, s[50:51] nt
    s_add_u32 s50, s50, 49152
    s_addc_u32 s51, s51, 0
    s_add_u32 m0, s5, 30720
    s_waitcnt vmcnt(4)
    global_load_lds_dwordx4 v1, s[50:51] nt
    s_add_u32 s50, s50, 49152
    s_addc_u32 s51, s51, 0
    s_add_u32 m0, s5, 31744
    s_waitcnt vmcnt(4)
    global_load_lds_dwordx4 v2, s[50:51] nt
    v_lshrrev_b32 v1, 4, v0
    v_bfe_u32 v2, v0, 2, 2
    v_lshl_add_u32 v3, v1, 3, v2
    v_lshlrev_b32 v8, 7, v3
    v_lshrrev_b32 v2, 1, v2
    v_and_b32 v3, 1, v1
    v_lshl_add_u32 v2, v3, 1, v2
    v_xor_b32 v2, s70, v2
    v_lshl_add_u32 v8, v2, 5, v8
    v_and_b32 v2, 3, v0
    v_lshl_add_u32 v8, v2, 3, v8
    v_add_u32 v8, 16384, v8
    v_and_b32 v2, 1, v0
    v_mul_u32_u24 v2, 1088, v2
    v_lshl_add_u32 v9, v1, 4, v2
    v_add_u32 v9, 0, v9
    v_and_b32 v1, 1, v0
    v_lshlrev_b32 v1, 5, v1
    v_lshrrev_b32 v2, 4, v0
    v_lshl_add_u32 v1, v2, 3, v1
    s_lshl_b32 s4, s48, 8
    s_lshl_b32 s5, s70, 6
    s_add_u32 s4, s4, s5
    s_add_u32 s4, s4, 61440
    v_add_u32 v10, s4, v1
    s_waitcnt vmcnt(16)
    v_lshlrev_b32 v72, 16, v70
    v_and_b32 v73, s55, v70
    v_lshlrev_b32 v74, 16, v71
    v_and_b32 v75, s55, v71
    v_mul_f32 v76, s53, v72
    v_mul_f32 v77, s53, v73
    v_mul_f32 v78, s53, v74
    v_mul_f32 v79, s53, v75
    v_exp_f32 v76, -v76
    v_exp_f32 v77, -v77
    v_exp_f32 v78, -v78
    v_exp_f32 v79, -v79
    v_add_f32 v76, 1.0, v76
    v_add_f32 v77, 1.0, v77
    v_add_f32 v78, 1.0, v78
    v_add_f32 v79, 1.0, v79
    v_rcp_f32 v76, v76
    v_rcp_f32 v77, v77
    v_rcp_f32 v78, v78
    v_rcp_f32 v79, v79
    v_mul_f32 v72, v72, v76
    v_mul_f32 v73, v73, v77
    v_mul_f32 v74, v74, v78
    v_mul_f32 v75, v75, v79
    v_cvt_pk_bf16_f32 v72, v72, v73
    v_cvt_pk_bf16_f32 v73, v74, v75
    s_lshr_b32 s4, s70, 1
    s_mul_i32 s4, s4, 64
    s_add_u32 s4, s4, 0
    v_add_u32 v69, s4, v69
    ds_write_b64 v69, v[72:73]
    s_waitcnt vmcnt(0)
    v_mov_b32 v1, 11072
    v_mov_b32 v2, 1
    s_waitcnt lgkmcnt(0)
    s_mov_b64 exec, 1
    ds_add_u32 v1, v2
    s_mov_b64 exec, -1
    v_mov_b32 v1, 11072
L_lw_19:
    ds_read_b32 v2, v1
    s_waitcnt lgkmcnt(0)
    v_cmp_gt_u32 vcc, 4, v2
    s_cbranch_vccnz L_lw_19
    ds_read_b64_tr_b16 v[128:129], v8 offset:0
    ds_read_b64_tr_b16 v[130:131], v8 offset:512
    ds_read_b64_tr_b16 v[132:133], v8 offset:4096
    ds_read_b64_tr_b16 v[134:135], v8 offset:4608
    ds_read_b64_tr_b16 v[136:137], v8 offset:8192
    ds_read_b64_tr_b16 v[138:139], v8 offset:8704
    ds_read_b64_tr_b16 v[140:141], v8 offset:12288
    ds_read_b64_tr_b16 v[142:143], v8 offset:12800
    ds_read_b64_tr_b16 v[144:145], v8 offset:16384
    ds_read_b64_tr_b16 v[146:147], v8 offset:16896
    ds_read_b64_tr_b16 v[148:149], v8 offset:20480
    ds_read_b64_tr_b16 v[150:151], v8 offset:20992
    ds_read_b64_tr_b16 v[152:153], v8 offset:24576
    ds_read_b64_tr_b16 v[154:155], v8 offset:25088
    ds_read_b64_tr_b16 v[156:157], v8 offset:28672
    ds_read_b64_tr_b16 v[158:159], v8 offset:29184
    ds_read_b64_tr_b16 v[160:161], v8 offset:32768
    ds_read_b64_tr_b16 v[162:163], v8 offset:33280
    ds_read_b64_tr_b16 v[164:165], v8 offset:36864
    ds_read_b64_tr_b16 v[166:167], v8 offset:37376
    ds_read_b64_tr_b16 v[168:169], v8 offset:40960
    ds_read_b64_tr_b16 v[170:171], v8 offset:41472
    ds_read_b64_tr_b16 v[172:173], v8 offset:45056
    ds_read_b64_tr_b16 v[174:175], v8 offset:45568
    ds_read_b64_tr_b16 v[176:177], v8 offset:49152
    ds_read_b64_tr_b16 v[178:179], v8 offset:49664
    ds_read_b64_tr_b16 v[180:181], v8 offset:53248
    ds_read_b64_tr_b16 v[182:183], v8 offset:53760
    ds_read_b64_tr_b16 v[184:185], v8 offset:57344
    ds_read_b64_tr_b16 v[186:187], v8 offset:57856
    ds_read_b64_tr_b16 v[188:189], v8 offset:61440
    ds_read_b64_tr_b16 v[190:191], v8 offset:61952
    ds_read_b128 v[192:195], v9 offset:0
    ds_read_b128 v[196:199], v9 offset:64
    ds_read_b128 v[200:203], v9 offset:128
    ds_read_b128 v[204:207], v9 offset:192
    ds_read_b128 v[208:211], v9 offset:256
    ds_read_b128 v[212:215], v9 offset:320
    ds_read_b128 v[216:219], v9 offset:384
    ds_read_b128 v[220:223], v9 offset:448
    ds_read_b128 v[224:227], v9 offset:512
    ds_read_b128 v[228:231], v9 offset:576
    ds_read_b128 v[232:235], v9 offset:640
    ds_read_b128 v[236:239], v9 offset:704
    ds_read_b128 v[240:243], v9 offset:768
    ds_read_b128 v[244:247], v9 offset:832
    ds_read_b128 v[248:251], v9 offset:896
    ds_read_b128 v[252:255], v9 offset:960
    s_waitcnt lgkmcnt(12)
    v_mfma_f32_16x16x32_bf16 v[16:19], v[128:131], v[192:195], 0
    v_mfma_f32_16x16x32_bf16 v[16:19], v[132:135], v[196:199], v[16:19]
    v_mfma_f32_16x16x32_bf16 v[16:19], v[136:139], v[200:203], v[16:19]
    v_mfma_f32_16x16x32_bf16 v[16:19], v[140:143], v[204:207], v[16:19]
    s_waitcnt lgkmcnt(8)
    v_mfma_f32_16x16x32_bf16 v[16:19], v[144:147], v[208:211], v[16:19]
    v_mfma_f32_16x16x32_bf16 v[16:19], v[148:151], v[212:215], v[16:19]
    v_mfma_f32_16x16x32_bf16 v[16:19], v[152:155], v[216:219], v[16:19]
    v_mfma_f32_16x16x32_bf16 v[16:19], v[156:159], v[220:223], v[16:19]
    s_waitcnt lgkmcnt(4)
    v_mfma_f32_16x16x32_bf16 v[16:19], v[160:163], v[224:227], v[16:19]
    v_mfma_f32_16x16x32_bf16 v[16:19], v[164:167], v[228:231], v[16:19]
    v_mfma_f32_16x16x32_bf16 v[16:19], v[168:171], v[232:235], v[16:19]
    v_mfma_f32_16x16x32_bf16 v[16:19], v[172:175], v[236:239], v[16:19]
    s_waitcnt lgkmcnt(0)
    v_mfma_f32_16x16x32_bf16 v[16:19], v[176:179], v[240:243], v[16:19]
    v_mfma_f32_16x16x32_bf16 v[16:19], v[180:183], v[244:247], v[16:19]
    v_mfma_f32_16x16x32_bf16 v[16:19], v[184:187], v[248:251], v[16:19]
    v_mfma_f32_16x16x32_bf16 v[16:19], v[188:191], v[252:255], v[16:19]
    s_nop 7
    v_cvt_pk_bf16_f32 v16, v16, v17
    v_cvt_pk_bf16_f32 v17, v18, v19
    v_min_u32 v16, -2, v16
    v_min_u32 v17, -2, v17
    s_mov_b32 exec_lo, 0x00030003
    s_mov_b32 exec_hi, 0x00030003
    global_store_dwordx2 v10, v[16:17], s[34:35] sc1
    s_mov_b64 exec, -1
    s_branch L_hexit
L_P2:
    s_sub_u32 s48, s96, 64
    s_and_b32 s4, s70, 1
    s_lshl_b32 s4, s4, 10
    v_lshl_add_u32 v69, v0, 4, s4
    global_load_dwordx4 v[72:75], v69, s[8:9]
    s_barrier
    s_lshl_b32 s6, s48, 7
    v_lshrrev_b32 v3, 3, v0
    v_mov_b32 v1, v3
    v_mul_u32_u24 v1, 8192, v1
    v_and_b32 v3, 2, v3
    v_and_b32 v2, 7, v0
    v_xor_b32 v2, v2, v3
    v_lshlrev_b32 v2, 4, v2
    v_add_u32 v1, v1, v2
    v_xor_b32 v2, 64, v1
    s_mul_i32 s4, s70, 1048576
    s_add_u32 s4, s4, s6
    s_add_u32 s50, s14, s4
    s_addc_u32 s51, s15, 0
    s_lshl_b32 s5, s70, 14
    s_add_u32 m0, s5, 16384
    s_nop 0
    global_load_lds_dwordx4 v1, s[50:51] nt
    s_add_u32 s50, s50, 65536
    s_addc_u32 s51, s51, 0
    s_add_u32 m0, s5, 17408
    s_nop 0
    global_load_lds_dwordx4 v2, s[50:51] nt
    s_add_u32 s50, s50, 65536
    s_addc_u32 s51, s51, 0
    s_add_u32 m0, s5, 18432
    s_nop 0
    global_load_lds_dwordx4 v1, s[50:51] nt
    s_add_u32 s50, s50, 65536
    s_addc_u32 s51, s51, 0
    s_add_u32 m0, s5, 19456
    s_nop 0
    global_load_lds_dwordx4 v2, s[50:51] nt
    s_add_u32 s50, s50, 65536
    s_addc_u32 s51, s51, 0
    s_add_u32 m0, s5, 20480
    s_nop 0
    global_load_lds_dwordx4 v1, s[50:51] nt
    s_add_u32 s50, s50, 65536
    s_addc_u32 s51, s51, 0
    s_add_u32 m0, s5, 21504
    s_nop 0
    global_load_lds_dwordx4 v2, s[50:51] nt
    s_add_u32 s50, s50, 65536
    s_addc_u32 s51, s51, 0
    s_add_u32 m0, s5, 22528
    s_nop 0
    global_load_lds_dwordx4 v1, s[50:51] nt
    s_add_u32 s50, s50, 65536
    s_addc_u32 s51, s51, 0
    s_add_u32 m0, s5, 23552
    s_nop 0
    global_load_lds_dwordx4 v2, s[50:51] nt
    s_add_u32 s50, s50, 65536
    s_addc_u32 s51, s51, 0
    s_add_u32 m0, s5, 24576
    s_nop 0
    global_load_lds_dwordx4 v1, s[50:51] nt
    s_add_u32 s50, s50, 65536
    s_addc_u32 s51, s51, 0
    s_add_u32 m0, s5, 25600
    s_nop 0
    global_load_lds_dwordx4 v2, s[50:51] nt
    s_add_u32 s50, s50, 65536
    s_addc_u32 s51, s51, 0
    s_add_u32 m0, s5, 26624
    s_nop 0
    global_load_lds_dwordx4 v1, s[50:51] nt
    s_add_u32 s50, s50, 65536
    s_addc_u32 s51, s51, 0
    s_add_u32 m0, s5, 27648
    s_nop 0
    global_load_lds_dwordx4 v2, s[50:51] nt
    s_add_u32 s50, s50, 65536
    s_addc_u32 s51, s51, 0
    s_add_u32 m0, s5, 28672
    s_nop 0
    global_load_lds_dwordx4 v1, s[50:51] nt
    s_add_u32 s50, s50, 65536
    s_addc_u32 s51, s51, 0
    s_add_u32 m0, s5, 29696
    s_nop 0
    global_load_lds_dwordx4 v2, s[50:51] nt
    s_add_u32 s50, s50, 65536
    s_addc_u32 s51, s51, 0
    s_add_u32 m0, s5, 30720
    s_nop 0
    global_load_lds_dwordx4 v1, s[50:51] nt
    s_add_u32 s50, s50, 65536
    s_addc_u32 s51, s51, 0
    s_add_u32 m0, s5, 31744
    s_nop 0
    global_load_lds_dwordx4 v2, s[50:51] nt
    v_lshrrev_b32 v1, 4, v0
    v_bfe_u32 v2, v0, 2, 2
    v_lshl_add_u32 v3, v1, 3, v2
    v_lshlrev_b32 v8, 7, v3
    v_lshrrev_b32 v2, 1, v2
    v_and_b32 v3, 1, v1
    v_lshl_add_u32 v2, v3, 1, v2
    v_xor_b32 v2, s70, v2
    v_lshl_add_u32 v8, v2, 5, v8
    v_and_b32 v2, 3, v0
    v_lshl_add_u32 v8, v2, 3, v8
    v_add_u32 v8, 16384, v8
    v_and_b32 v2, 1, v0
    v_mul_u32_u24 v2, 1088, v2
    v_lshl_add_u32 v9, v1, 4, v2
    v_add_u32 v9, 0, v9
    v_and_b32 v1, 1, v0
    v_lshlrev_b32 v1, 5, v1
    v_lshrrev_b32 v2, 4, v0
    v_lshl_add_u32 v1, v2, 3, v1
    s_lshl_b32 s4, s48, 8
    s_lshl_b32 s5, s70, 6
    s_add_u32 s4, s4, s5
    s_add_u32 s4, s4, 16384
    v_add_u32 v10, s4, v1
    s_waitcnt vmcnt(16)
    s_cmp_ge_u32 s70, 2
    s_cbranch_scc1 L_P2_a
    v_lshlrev_b32 v76, 16, v72
    v_and_b32 v77, s55, v72
    v_lshlrev_b32 v78, 16, v73
    v_and_b32 v79, s55, v73
    v_lshlrev_b32 v80, 16, v74
    v_and_b32 v81, s55, v74
    v_lshlrev_b32 v82, 16, v75
    v_and_b32 v83, s55, v75
    v_readfirstlane_b32 s71, v76
    s_nop 1
    v_subrev_f32 v84, s71, v76
    v_subrev_f32 v85, s71, v77
    v_subrev_f32 v86, s71, v78
    v_subrev_f32 v87, s71, v79
    v_subrev_f32 v88, s71, v80
    v_subrev_f32 v89, s71, v81
    v_subrev_f32 v90, s71, v82
    v_subrev_f32 v91, s71, v83
    v_add_f32 v92, v84, v85
    v_mul_f32 v93, v84, v84
    v_fmac_f32 v93, v85, v85
    v_add_f32 v92, v92, v86
    v_fmac_f32 v93, v86, v86
    v_add_f32 v92, v92, v87
    v_fmac_f32 v93, v87, v87
    v_add_f32 v92, v92, v88
    v_fmac_f32 v93, v88, v88
    v_add_f32 v92, v92, v89
    v_fmac_f32 v93, v89, v89
    v_add_f32 v92, v92, v90
    v_fmac_f32 v93, v90, v90
    v_add_f32 v92, v92, v91
    v_fmac_f32 v93, v91, v91
    s_nop 0
    v_add_f32_dpp v92, v92, v92 row_ror:8 row_mask:0xf bank_mask:0xf
    v_add_f32_dpp v93, v93, v93 row_ror:8 row_mask:0xf bank_mask:0xf
    s_nop 0
    v_add_f32_dpp v92, v92, v92 row_ror:4 row_mask:0xf bank_mask:0xf
    v_add_f32_dpp v93, v93, v93 row_ror:4 row_mask:0xf bank_mask:0xf
    s_nop 0
    v_add_f32_dpp v92, v92, v92 row_ror:2 row_mask:0xf bank_mask:0xf
    v_add_f32_dpp v93, v93, v93 row_ror:2 row_mask:0xf bank_mask:0xf
    s_nop 0
    v_add_f32_dpp v92, v92, v92 row_ror:1 row_mask:0xf bank_mask:0xf
    v_add_f32_dpp v93, v93, v93 row_ror:1 row_mask:0xf bank_mask:0xf
    s_nop 0
    v_add_f32_dpp v92, v92, v92 row_bcast:15 row_mask:0xa bank_mask:0xf
    v_add_f32_dpp v93, v93, v93 row_bcast:15 row_mask:0xa bank_mask:0xf
    s_nop 0
    v_add_f32_dpp v92, v92, v92 row_bcast:31 row_mask:0xc bank_mask:0xf
    v_add_f32_dpp v93, v93, v93 row_bcast:31 row_mask:0xc bank_mask:0xf
    v_readlane_b32 s67, v92, 63
    v_readlane_b32 s7, v93, 63
    v_mov_b32 v95, 0x3b000000
    v_mul_f32 v93, s67, v95
    v_mul_f32 v94, s7, v95
    v_fma_f32 v94, -v93, v93, v94
    v_add_f32 v93, s71, v93
    v_max_f32 v94, 0, v94
    v_cvt_pk_bf16_f32 v92, v93, v94
    v_lshlrev_b32 v93, 16, v92
    v_and_b32 v94, s55, v92
    v_add_f32 v94, 0x3727c5ac, v94
    v_sub_f32 v84, v76, v93
    v_sub_f32 v85, v77, v93
    v_sub_f32 v86, v78, v93
    v_sub_f32 v87, v79, v93
    v_sub_f32 v88, v80, v93
    v_sub_f32 v89, v81, v93
    v_sub_f32 v90, v82, v93
    v_sub_f32 v91, v83, v93
    v_cvt_pk_bf16_f32 v94, v94, v94
    v_and_b32 v94, s55, v94
    v_sqrt_f32 v94, v94
    v_cvt_pk_bf16_f32 v92, v84, v85
    v_lshlrev_b32 v84, 16, v92
    v_and_b32 v85, s55, v92
    v_cvt_pk_bf16_f32 v93, v86, v87
    v_lshlrev_b32 v86, 16, v93
    v_and_b32 v87, s55, v93
    v_cvt_pk_bf16_f32 v94, v94, v94
    v_and_b32 v94, s55, v94
    v_rcp_f32 v94, v94
    v_cvt_pk_bf16_f32 v92, v88, v89
    v_lshlrev_b32 v88, 16, v92
    v_and_b32 v89, s55, v92
    v_cvt_pk_bf16_f32 v93, v90, v91
    v_lshlrev_b32 v90, 16, v93
    v_and_b32 v91, s55, v93
    v_mul_f32 v84, v84, v94
    v_mul_f32 v85, v85, v94
    v_mul_f32 v86, v86, v94
    v_mul_f32 v87, v87, v94
    v_mul_f32 v88, v88, v94
    v_mul_f32 v89, v89, v94
    v_mul_f32 v90, v90, v94
    v_mul_f32 v91, v91, v94
    v_cvt_pk_bf16_f32 v92, v84, v85
    v_lshlrev_b32 v84, 16, v92
    v_and_b32 v85, s55, v92
    v_cvt_pk_bf16_f32 v93, v86, v87
    v_lshlrev_b32 v86, 16, v93
    v_and_b32 v87, s55, v93
    v_cvt_pk_bf16_f32 v92, v88, v89
    v_lshlrev_b32 v88, 16, v92
    v_and_b32 v89, s55, v92
    v_cvt_pk_bf16_f32 v93, v90, v91
    v_lshlrev_b32 v90, 16, v93
    v_and_b32 v91, s55, v93
    v_and_b32 v3, 1, v0
    v_lshlrev_b32 v3, 2, v3
    s_mov_b32 s52, 262144
L_spin_20:
    global_load_dword v2, v3, s[32:33] sc1
    s_waitcnt vmcnt(0)
    v_cmp_eq_u32 vcc, 0, v2
    s_cbranch_vccz L_spindone_21
    s_sub_u32 s52, s52, 1
    s_cmp_lg_u32 s52, 0
    s_cbranch_scc1 L_spin_20
L_spindone_21:
L_P2_a:
    s_waitcnt vmcnt(0)
    v_mov_b32 v1, 11072
    v_mov_b32 v2, 1
    s_waitcnt lgkmcnt(0)
    s_mov_b64 exec, 1
    ds_add_u32 v1, v2
    s_mov_b64 exec, -1
    v_mov_b32 v1, 11072
L_lw_22:
    ds_read_b32 v2, v1
    s_waitcnt lgkmcnt(0)
    v_cmp_gt_u32 vcc, 4, v2
    s_cbranch_vccnz L_lw_22
    ds_read_b64_tr_b16 v[128:129], v8 offset:0
    ds_read_b64_tr_b16 v[130:131], v8 offset:512
    ds_read_b64_tr_b16 v[132:133], v8 offset:4096
    ds_read_b64_tr_b16 v[134:135], v8 offset:4608
    ds_read_b64_tr_b16 v[136:137], v8 offset:8192
    ds_read_b64_tr_b16 v[138:139], v8 offset:8704
    ds_read_b64_tr_b16 v[140:141], v8 offset:12288
    ds_read_b64_tr_b16 v[142:143], v8 offset:12800
    ds_read_b64_tr_b16 v[144:145], v8 offset:16384
    ds_read_b64_tr_b16 v[146:147], v8 offset:16896
    ds_read_b64_tr_b16 v[148:149], v8 offset:20480
    ds_read_b64_tr_b16 v[150:151], v8 offset:20992
    ds_read_b64_tr_b16 v[152:153], v8 offset:24576
    ds_read_b64_tr_b16 v[154:155], v8 offset:25088
    ds_read_b64_tr_b16 v[156:157], v8 offset:28672
    ds_read_b64_tr_b16 v[158:159], v8 offset:29184
    ds_read_b64_tr_b16 v[160:161], v8 offset:32768
    ds_read_b64_tr_b16 v[162:163], v8 offset:33280
    ds_read_b64_tr_b16 v[164:165], v8 offset:36864
    ds_read_b64_tr_b16 v[166:167], v8 offset:37376
    ds_read_b64_tr_b16 v[168:169], v8 offset:40960
    ds_read_b64_tr_b16 v[170:171], v8 offset:41472
    ds_read_b64_tr_b16 v[172:173], v8 offset:45056
    ds_read_b64_tr_b16 v[174:175], v8 offset:45568
    ds_read_b64_tr_b16 v[176:177], v8 offset:49152
    ds_read_b64_tr_b16 v[178:179], v8 offset:49664
    ds_read_b64_tr_b16 v[180:181], v8 offset:53248
    ds_read_b64_tr_b16 v[182:183], v8 offset:53760
    ds_read_b64_tr_b16 v[184:185], v8 offset:57344
    ds_read_b64_tr_b16 v[186:187], v8 offset:57856
    ds_read_b64_tr_b16 v[188:189], v8 offset:61440
    ds_read_b64_tr_b16 v[190:191], v8 offset:61952
    s_cmp_ge_u32 s70, 2
    s_cbranch_scc1 L_P2_b
    v_lshrrev_b32 v1, 1, v0
    v_lshlrev_b32 v1, 6, v1
    v_and_b32 v2, 1, v0
    v_lshl_add_u32 v1, v2, 4, v1
    s_lshl_b32 s4, s70, 5
    s_add_u32 s4, s4, 0
    v_add_u32 v3, s4, v1
    s_mul_i32 s4, s70, 1088
    s_add_u32 s4, s4, 0
    v_lshl_add_u32 v69, v0, 4, s4
    s_mov_b32 s52, 262144
L_spin_23:
    global_load_dwordx4 v[96:99], v3, s[34:35] sc1
    global_load_dwordx4 v[100:103], v3, s[34:35] offset:2048 sc1
    s_waitcnt vmcnt(0)
    v_max3_u32 v92, v96, v97, v98
    v_max3_u32 v92, v92, v99, v100
    v_max3_u32 v92, v92, v101, v102
    v_max_u32 v92, v92, v103
    v_cmp_eq_u32 vcc, -1, v92
    s_cbranch_vccz L_spindone_24
    s_sub_u32 s52, s52, 1
    s_cmp_lg_u32 s52, 0
    s_cbranch_scc1 L_spin_23
L_spindone_24:
    v_lshlrev_b32 v104, 16, v100
    v_and_b32 v105, s55, v100
    v_lshlrev_b32 v106, 16, v101
    v_and_b32 v107, s55, v101
    v_lshlrev_b32 v108, 16, v102
    v_and_b32 v109, s55, v102
    v_lshlrev_b32 v110, 16, v103
    v_and_b32 v111, s55, v103
    v_lshlrev_b32 v112, 16, v96
    v_and_b32 v113, s55, v96
    v_lshlrev_b32 v114, 16, v97
    v_and_b32 v115, s55, v97
    v_lshlrev_b32 v116, 16, v98
    v_and_b32 v117, s55, v98
    v_lshlrev_b32 v118, 16, v99
    v_and_b32 v119, s55, v99
    v_add_f32 v104, 1.0, v104
    v_add_f32 v105, 1.0, v105
    v_add_f32 v106, 1.0, v106
    v_add_f32 v107, 1.0, v107
    v_add_f32 v108, 1.0, v108
    v_add_f32 v109, 1.0, v109
    v_add_f32 v110, 1.0, v110
    v_add_f32 v111, 1.0, v111
    v_cvt_pk_bf16_f32 v120, v104, v105
    v_lshlrev_b32 v104, 16, v120
    v_and_b32 v105, s55, v120
    v_cvt_pk_bf16_f32 v121, v106, v107
    v_lshlrev_b32 v106, 16, v121
    v_and_b32 v107, s55, v121
    v_cvt_pk_bf16_f32 v120, v108, v109
    v_lshlrev_b32 v108, 16, v120
    v_and_b32 v109, s55, v120
    v_cvt_pk_bf16_f32 v121, v110, v111
    v_lshlrev_b32 v110, 16, v121
    v_and_b32 v111, s55, v121
    v_mul_f32 v104, v104, v84
    v_mul_f32 v105, v105, v85
    v_mul_f32 v106, v106, v86
    v_mul_f32 v107, v107, v87
    v_mul_f32 v108, v108, v88
    v_mul_f32 v109, v109, v89
    v_mul_f32 v110, v110, v90
    v_mul_f32 v111, v111, v91
    v_cvt_pk_bf16_f32 v120, v104, v105
    v_lshlrev_b32 v104, 16, v120
    v_and_b32 v105, s55, v120
    v_cvt_pk_bf16_f32 v121, v106, v107
    v_lshlrev_b32 v106, 16, v121
    v_and_b32 v107, s55, v121
    v_cvt_pk_bf16_f32 v120, v108, v109
    v_lshlrev_b32 v108, 16, v120
    v_and_b32 v109, s55, v120
    v_cvt_pk_bf16_f32 v121, v110, v111
    v_lshlrev_b32 v110, 16, v121
    v_and_b32 v111, s55, v121
    v_add_f32 v104, v104, v112
    v_add_f32 v105, v105, v113
    v_add_f32 v106, v106, v114
    v_add_f32 v107, v107, v115
    v_add_f32 v108, v108, v116
    v_add_f32 v109, v109, v117
    v_add_f32 v110, v110, v118
    v_add_f32 v111, v111, v119
    v_cvt_pk_bf16_f32 v72, v104, v105
    v_cvt_pk_bf16_f32 v73, v106, v107
    v_cvt_pk_bf16_f32 v74, v108, v109
    v_cvt_pk_bf16_f32 v75, v110, v111
    ds_write_b128 v69, v[72:75]
    v_mov_b32 v1, 11076
    v_mov_b32 v2, 1
    s_waitcnt lgkmcnt(0)
    s_mov_b64 exec, 1
    ds_add_u32 v1, v2
    s_mov_b64 exec, -1
L_P2_b:
    v_mov_b32 v1, 11076
L_lw_25:
    ds_read_b32 v2, v1
    s_waitcnt lgkmcnt(0)
    v_cmp_gt_u32 vcc, 2, v2
    s_cbranch_vccnz L_lw_25
    ds_read_b128 v[192:195], v9 offset:0
    ds_read_b128 v[196:199], v9 offset:64
    ds_read_b128 v[200:203], v9 offset:128
    ds_read_b128 v[204:207], v9 offset:192
    ds_read_b128 v[208:211], v9 offset:256
    ds_read_b128 v[212:215], v9 offset:320
    ds_read_b128 v[216:219], v9 offset:384
    ds_read_b128 v[220:223], v9 offset:448
    ds_read_b128 v[224:227], v9 offset:512
    ds_read_b128 v[228:231], v9 offset:576
    ds_read_b128 v[232:235], v9 offset:640
    ds_read_b128 v[236:239], v9 offset:704
    ds_read_b128 v[240:243], v9 offset:768
    ds_read_b128 v[244:247], v9 offset:832
    ds_read_b128 v[248:251], v9 offset:896
    ds_read_b128 v[252:255], v9 offset:960
    s_waitcnt lgkmcnt(12)
    v_mfma_f32_16x16x32_bf16 v[16:19], v[128:131], v[192:195], 0
    v_mfma_f32_16x16x32_bf16 v[16:19], v[132:135], v[196:199], v[16:19]
    v_mfma_f32_16x16x32_bf16 v[16:19], v[136:139], v[200:203], v[16:19]
    v_mfma_f32_16x16x32_bf16 v[16:19], v[140:143], v[204:207], v[16:19]
    s_waitcnt lgkmcnt(8)
    v_mfma_f32_16x16x32_bf16 v[16:19], v[144:147], v[208:211], v[16:19]
    v_mfma_f32_16x16x32_bf16 v[16:19], v[148:151], v[212:215], v[16:19]
    v_mfma_f32_16x16x32_bf16 v[16:19], v[152:155], v[216:219], v[16:19]
    v_mfma_f32_16x16x32_bf16 v[16:19], v[156:159], v[220:223], v[16:19]
    s_waitcnt lgkmcnt(4)
    v_mfma_f32_16x16x32_bf16 v[16:19], v[160:163], v[224:227], v[16:19]
    v_mfma_f32_16x16x32_bf16 v[16:19], v[164:167], v[228:231], v[16:19]
    v_mfma_f32_16x16x32_bf16 v[16:19], v[168:171], v[232:235], v[16:19]
    v_mfma_f32_16x16x32_bf16 v[16:19], v[172:175], v[236:239], v[16:19]
    s_waitcnt lgkmcnt(0)
    v_mfma_f32_16x16x32_bf16 v[16:19], v[176:179], v[240:243], v[16:19]
    v_mfma_f32_16x16x32_bf16 v[16:19], v[180:183], v[244:247], v[16:19]
    v_mfma_f32_16x16x32_bf16 v[16:19], v[184:187], v[248:251], v[16:19]
    v_mfma_f32_16x16x32_bf16 v[16:19], v[188:191], v[252:255], v[16:19]
    s_nop 7
    v_cvt_pk_bf16_f32 v16, v16, v17
    v_cvt_pk_bf16_f32 v17, v18, v19
    v_min_u32 v16, -2, v16
    v_min_u32 v17, -2, v17
    s_mov_b32 exec_lo, 0x00030003
    s_mov_b32 exec_hi, 0x00030003
    global_store_dwordx2 v10, v[16:17], s[34:35] sc1
    s_mov_b64 exec, -1
    s_cmp_lg_u32 s70, 0
    s_cbranch_scc1 L_hexit
    s_branch L_qwait
L_W0:
    s_sub_u32 s48, s96, 128
    s_mov_b32 s69, 1
    s_barrier
    s_and_b32 s4, s48, 7
    s_lshl_b32 s4, s4, 3
    s_lshr_b32 s48, s48, 3
    s_add_u32 s48, s48, s4
    s_cmp_lg_u32 s70, 0
    s_cbranch_scc1 L_W0_gate
    s_branch L_vote
L_W0_gate:
    v_and_b32 v3, 1, v0
    v_lshlrev_b32 v3, 2, v3
    s_mov_b32 s52, 262144
L_spin_26:
    global_load_dword v2, v3, s[32:33] sc1
    s_waitcnt vmcnt(0)
    v_cmp_eq_u32 vcc, 0, v2
    s_cbranch_vccz L_spindone_27
    s_sub_u32 s52, s52, 1
    s_cmp_lg_u32 s52, 0
    s_cbranch_scc1 L_spin_26
L_spindone_27:
    s_branch L_W0_go
L_M0:
    s_sub_u32 s48, s96, 192
    s_mov_b32 s69, 2
    s_barrier
    s_cmp_lg_u32 s70, 0
    s_cbranch_scc1 L_M0_gate
    s_branch L_vote
L_M0_gate:
    v_and_b32 v3, 1, v0
    v_lshlrev_b32 v3, 2, v3
    s_mov_b32 s52, 262144
L_spin_28:
    global_load_dword v2, v3, s[32:33] sc1
    s_waitcnt vmcnt(0)
    v_cmp_eq_u32 vcc, 0, v2
    s_cbranch_vccz L_spindone_29
    s_sub_u32 s52, s52, 1
    s_cmp_lg_u32 s52, 0
    s_cbranch_scc1 L_spin_28
L_spindone_29:
    s_branch L_M0_go
L_vote:
    s_lshl_b32 s6, s64, 23
    s_lshl_b32 s7, s93, 16
    s_add_u32 s6, s6, s7
    s_add_u32 s6, s6, 0x180000
    s_add_u32 s36, s10, s6
    s_addc_u32 s37, s11, 0
    s_add_u32 s38, s12, s6
    s_addc_u32 s39, s13, 0
    s_load_dword s4, s[36:37], 0x8000 glc
    s_load_dword s5, s[38:39], 0x8000 glc
    s_mov_b32 s56, -1
    s_mov_b32 s57, -1
    s_mov_b32 s58, -1
    s_mov_b32 s59, -1
    s_waitcnt lgkmcnt(0)
    s_memtime s[40:41]
    s_waitcnt lgkmcnt(0)
    s_mov_b32 s5, s40
    s_load_dword s4, s[36:37], 0x4b00 glc
    s_waitcnt lgkmcnt(0)
    s_memtime s[40:41]
    s_waitcnt lgkmcnt(0)
    s_sub_u32 s5, s40, s5
    s_min_u32 s56, s56, s5
    s_mov_b32 s5, s40
    s_load_dword s4, s[36:37], 0x6b00 glc
    s_waitcnt lgkmcnt(0)
    s_memtime s[40:41]
    s_waitcnt lgkmcnt(0)
    s_sub_u32 s5, s40, s5
    s_min_u32 s57, s57, s5
    s_mov_b32 s5, s40
    s_load_dword s4, s[38:39], 0x6b00 glc
    s_waitcnt lgkmcnt(0)
    s_memtime s[40:41]
    s_waitcnt lgkmcnt(0)
    s_sub_u32 s5, s40, s5
    s_min_u32 s59, s59, s5
    s_mov_b32 s5, s40
    s_load_dword s4, s[38:39], 0x4b00 glc
    s_waitcnt lgkmcnt(0)
    s_memtime s[40:41]
    s_waitcnt lgkmcnt(0)
    s_sub_u32 s5, s40, s5
    s_min_u32 s58, s58, s5
    s_mov_b32 s5, s40
    s_load_dword s4, s[36:37], 0x3600 glc
    s_waitcnt lgkmcnt(0)
    s_memtime s[40:41]
    s_waitcnt lgkmcnt(0)
    s_sub_u32 s5, s40, s5
    s_min_u32 s57, s57, s5
    s_mov_b32 s5, s40
    s_load_dword s4, s[36:37], 0x1600 glc
    s_waitcnt lgkmcnt(0)
    s_memtime s[40:41]
    s_waitcnt lgkmcnt(0)
    s_sub_u32 s5, s40, s5
    s_min_u32 s56, s56, s5
    s_mov_b32 s5, s40
    s_load_dword s4, s[38:39], 0x1600 glc
    s_waitcnt lgkmcnt(0)
    s_memtime s[40:41]
    s_waitcnt lgkmcnt(0)
    s_sub_u32 s5, s40, s5
    s_min_u32 s58, s58, s5
    s_mov_b32 s5, s40
    s_load_dword s4, s[38:39], 0x3600 glc
    s_waitcnt lgkmcnt(0)
    s_memtime s[40:41]
    s_waitcnt lgkmcnt(0)
    s_sub_u32 s5, s40, s5
    s_min_u32 s59, s59, s5
    s_mov_b32 s5, s40
    s_load_dword s4, s[36:37], 0x4100 glc
    s_waitcnt lgkmcnt(0)
    s_memtime s[40:41]
    s_waitcnt lgkmcnt(0)
    s_sub_u32 s5, s40, s5
    s_min_u32 s56, s56, s5
    s_mov_b32 s5, s40
    s_load_dword s4, s[36:37], 0x6100 glc
    s_waitcnt lgkmcnt(0)
    s_memtime s[40:41]
    s_waitcnt lgkmcnt(0)
    s_sub_u32 s5, s40, s5
    s_min_u32 s57, s57, s5
    s_mov_b32 s5, s40
    s_load_dword s4, s[38:39], 0x6100 glc
    s_waitcnt lgkmcnt(0)
    s_memtime s[40:41]
    s_waitcnt lgkmcnt(0)
    s_sub_u32 s5, s40, s5
    s_min_u32 s59, s59, s5
    s_mov_b32 s5, s40
    s_load_dword s4, s[38:39], 0x4100 glc
    s_waitcnt lgkmcnt(0)
    s_memtime s[40:41]
    s_waitcnt lgkmcnt(0)
    s_sub_u32 s5, s40, s5
    s_min_u32 s58, s58, s5
    s_getreg_b32 s7, hwreg(HW_REG_XCC_ID, 2, 1)
    s_cmp_lt_u32 s57, s56
    s_cselect_b32 s4, 1, 0
    s_cmp_lt_u32 s59, s58
    s_cselect_b32 s5, 1, 0
    s_xor_b32 s4, s4, s7
    s_xor_b32 s5, s5, s7
    s_lshl_b32 s4, s4, 8
    s_lshl_b32 s5, s5, 16
    s_or_b32 s47, s4, s5
    s_or_b32 s47, s47, 1
    v_and_b32 v3, 1, v0
    v_lshlrev_b32 v3, 2, v3
    s_mov_b32 s52, 262144
L_spin_30:
    global_load_dword v2, v3, s[32:33] sc1
    s_waitcnt vmcnt(0)
    v_cmp_eq_u32 vcc, 0, v2
    s_cbranch_vccz L_spindone_31
    s_sub_u32 s52, s52, 1
    s_cmp_lg_u32 s52, 0
    s_cbranch_scc1 L_spin_30
L_spindone_31:
    s_lshr_b32 s4, s64, 3
    s_lshl_b32 s4, s4, 8
    s_add_u32 s4, s4, 49152
    s_add_u32 s44, s34, s4
    s_addc_u32 s45, s35, 0
    s_mov_b32 s46, s47
    s_atomic_add s46, s[44:45], 0 glc
    s_waitcnt lgkmcnt(0)
    s_add_u32 s46, s46, s47
    s_and_b32 s4, s46, 0xff
    s_cmp_lg_u32 s4, 12
    s_cbranch_scc1 L_cv_32
    s_bfe_u32 s6, s46, 0x80008
    s_cmp_ge_u32 s6, 7
    s_cselect_b32 s4, 3, 6
    s_cmp_le_u32 s6, 5
    s_cselect_b32 s4, 2, s4
    s_bfe_u32 s6, s46, 0x80010
    s_cmp_ge_u32 s6, 7
    s_cselect_b32 s5, 3, 14
    s_cmp_le_u32 s6, 5
    s_cselect_b32 s5, 2, s5
    s_lshl_b32 s5, s5, 4
    s_or_b32 s4, s4, s5
    s_or_b32 s4, s4, 0x100
    v_mov_b32 v1, 128
    v_mov_b32 v2, s4
    s_mov_b64 exec, 1
    global_store_dword v1, v2, s[44:45] sc1
    s_mov_b64 exec, -1
L_cv_32:
    s_branch L_qwait
L_plain:
    s_cmp_lg_u32 s70, 0
    s_cbranch_scc1 L_hexit
L_qwait0:
    v_and_b32 v3, 1, v0
    v_lshlrev_b32 v3, 2, v3
    s_mov_b32 s52, 262144
L_spin_33:
    global_load_dword v2, v3, s[32:33] sc1
    s_waitcnt vmcnt(0)
    v_cmp_eq_u32 vcc, 0, v2
    s_cbranch_vccz L_spindone_34
    s_sub_u32 s52, s52, 1
    s_cmp_lg_u32 s52, 0
    s_cbranch_scc1 L_spin_33
L_spindone_34:
L_qwait:
    s_lshl_b32 s4, s64, 7
    s_add_u32 s4, s4, 57344
    v_mov_b32 v14, s4
    s_add_u32 s44, s34, s4
    s_addc_u32 s45, s35, 0
    s_getreg_b32 s7, hwreg(HW_REG_XCC_ID, 2, 1)
    s_lshl_b32 s47, s7, s93
    s_or_b32 s47, s47, 0x100
    s_atomic_add s47, s[44:45], 0
    s_lshr_b32 s4, s64, 3
    s_lshl_b32 s4, s4, 8
    s_add_u32 s4, s4, 49152
    s_add_u32 s44, s34, s4
    s_addc_u32 s45, s35, 0
    s_lshl_b32 s4, s65, 5
    s_lshl_b32 s5, s66, 9
    s_add_u32 s4, s4, s5
    s_add_u32 s4, s4, 16384
    v_lshrrev_b32 v1, 3, v0
    v_lshlrev_b32 v1, 6, v1
    v_and_b32 v2, 7, v0
    v_lshlrev_b32 v2, 2, v2
    v_add3_u32 v3, v1, v2, s4
    v_lshlrev_b32 v4, 2, v0
    v_mov_b32 v7, 128
    s_mov_b32 s52, 262144
L_spin_35:
    global_load_dword v15, v14, s[34:35] sc1
    global_load_dword v6, v7, s[44:45] sc1
    global_load_dword v5, v3, s[34:35] sc1
    s_waitcnt vmcnt(0)
    v_cmp_eq_u32 vcc, -1, v5
    s_cbranch_vccz L_spindone_36
    s_sub_u32 s52, s52, 1
    s_cmp_lg_u32 s52, 0
    s_cbranch_scc1 L_spin_35
L_spindone_36:
    ds_write_b32 v4, v5 offset:2304
    v_lshrrev_b32 v1, 10, v15
    v_min_u32 v1, v1, v6
    v_cmp_eq_u32 vcc, 0, v1
    s_cbranch_vccnz L_votelate
    v_readfirstlane_b32 s46, v6
    v_readfirstlane_b32 s6, v15
    s_nop 0
    s_lshr_b32 s7, s6, 2
    s_xor_b32 s6, s6, s7
    s_and_b32 s6, s6, 3
    s_cmp_eq_u32 s6, 3
    s_cselect_b32 s46, s46, 0x1e6
    s_getreg_b32 s7, hwreg(HW_REG_XCC_ID, 2, 1)
    s_bfe_u32 s4, s46, 0x40000
    s_or_b32 s4, s4, 2
    s_xor_b32 s4, s4, s7
    s_bfe_u32 s5, s46, 0x40004
    s_or_b32 s5, s5, 2
    s_xor_b32 s5, s5, s7
    v_mov_b32 v1, 11088
    v_mov_b32 v2, s4
    v_mov_b32 v3, s5
    ds_write_b64 v1, v[2:3]
    v_mov_b32 v1, 11080
    v_mov_b32 v2, 1
    s_waitcnt lgkmcnt(0)
    s_mov_b64 exec, 1
    ds_add_u32 v1, v2
    s_mov_b64 exec, -1
    s_branch L_votedone
L_votelate:
    v_mov_b32 v1, 11080
    v_mov_b32 v2, 1
    s_waitcnt lgkmcnt(0)
    s_mov_b64 exec, 1
    ds_add_u32 v1, v2
    s_mov_b64 exec, -1
    s_mov_b32 s52, 8192
L_vl0:
    global_load_dword v15, v14, s[34:35] sc1
    global_load_dword v6, v7, s[44:45] sc1
    s_waitcnt vmcnt(0)
    v_lshrrev_b32 v1, 10, v15
    v_min_u32 v1, v1, v6
    v_cmp_eq_u32 vcc, 0, v1
    s_cbranch_vccz L_vl1
    s_sub_u32 s52, s52, 1
    s_cmp_lg_u32 s52, 0
    s_cbranch_scc1 L_vl0
    v_mov_b32 v15, 0x403
    s_mov_b32 s52, 262144
L_spin_37:
    global_load_dword v6, v7, s[44:45] sc1
    s_waitcnt vmcnt(0)
    v_cmp_eq_u32 vcc, 0, v6
    s_cbranch_vccz L_spindone_38
    s_sub_u32 s52, s52, 1
    s_cmp_lg_u32 s52, 0
    s_cbranch_scc1 L_spin_37
L_spindone_38:
L_vl1:
    v_readfirstlane_b32 s46, v6
    v_readfirstlane_b32 s6, v15
    s_nop 0
    s_lshr_b32 s7, s6, 2
    s_xor_b32 s6, s6, s7
    s_and_b32 s6, s6, 3
    s_cmp_eq_u32 s6, 3
    s_cselect_b32 s46, s46, 0x1e6
    s_getreg_b32 s7, hwreg(HW_REG_XCC_ID, 2, 1)
    s_bfe_u32 s4, s46, 0x40000
    s_or_b32 s4, s4, 2
    s_xor_b32 s4, s4, s7
    s_bfe_u32 s5, s46, 0x40004
    s_or_b32 s5, s5, 2
    s_xor_b32 s5, s5, s7
    v_mov_b32 v1, 11088
    v_mov_b32 v2, s4
    v_mov_b32 v3, s5
    ds_write_b64 v1, v[2:3]
L_votedone:
    v_and_b32 v3, 3, v0
    v_lshlrev_b32 v3, 2, v3
    s_mov_b32 s7, 0x01010101
    s_mov_b32 s52, 262144
L_spin_39:
    global_load_dword v2, v3, s[32:33] offset:128 sc1
    s_waitcnt vmcnt(0)
    v_cmp_ne_u32 vcc, s7, v2
    s_cbranch_vccz L_spindone_40
    s_sub_u32 s52, s52, 1
    s_cmp_lg_u32 s52, 0
    s_cbranch_scc1 L_spin_39
L_spindone_40:
    v_mov_b32 v1, 11084
    v_mov_b32 v2, 1
    s_waitcnt lgkmcnt(0)
    s_mov_b64 exec, 1
    ds_add_u32 v1, v2
    s_mov_b64 exec, -1
    s_cmp_eq_u32 s69, 0
    s_cbranch_scc1 L_fin
    s_cmp_eq_u32 s69, 3
    s_cbranch_scc1 L_P1b_go
    s_cmp_eq_u32 s69, 2
    s_cbranch_scc1 L_M0_go
L_W0_go:
    s_lshr_b32 s6, s48, 3
    s_lshl_b32 s6, s6, 19
    s_and_b32 s7, s48, 7
    s_lshl_b32 s7, s7, 7
    s_add_u32 s6, s6, s7
    v_lshrrev_b32 v3, 3, v0
    v_and_b32 v1, 3, v3
    v_lshlrev_b32 v1, 3, v1
    v_lshrrev_b32 v2, 2, v3
    v_add_u32 v1, v1, v2
    v_mul_u32_u24 v1, 1024, v1
    v_and_b32 v3, 2, v3
    v_and_b32 v2, 7, v0
    v_xor_b32 v2, v2, v3
    v_lshlrev_b32 v2, 4, v2
    v_add_u32 v1, v1, v2
    v_xor_b32 v2, 64, v1
    s_mul_i32 s4, s70, 131072
    s_add_u32 s4, s4, s6
    s_add_u32 s50, s16, s4
    s_addc_u32 s51, s17, 0
    s_lshl_b32 s5, s70, 14
    s_add_u32 m0, s5, 16384
    s_nop 0
    global_load_lds_dwordx4 v1, s[50:51] nt
    s_add_u32 s50, s50, 2048
    s_addc_u32 s51, s51, 0
    s_add_u32 m0, s5, 17408
    s_nop 0
    global_load_lds_dwordx4 v2, s[50:51] nt
    s_add_u32 s50, s50, 2048
    s_addc_u32 s51, s51, 0
    s_add_u32 m0, s5, 18432
    s_nop 0
    global_load_lds_dwordx4 v1, s[50:51] nt
    s_add_u32 s50, s50, 2048
    s_addc_u32 s51, s51, 0
    s_add_u32 m0, s5, 19456
    s_nop 0
    global_load_lds_dwordx4 v2, s[50:51] nt
    s_add_u32 s50, s50, 26624
    s_addc_u32 s51, s51, 0
    s_add_u32 m0, s5, 20480
    s_nop 0
    global_load_lds_dwordx4 v1, s[50:51] nt
    s_add_u32 s50, s50, 2048
    s_addc_u32 s51, s51, 0
    s_add_u32 m0, s5, 21504
    s_waitcnt vmcnt(4)
    global_load_lds_dwordx4 v2, s[50:51] nt
    s_add_u32 s50, s50, 2048
    s_addc_u32 s51, s51, 0
    s_add_u32 m0, s5, 22528
    s_waitcnt vmcnt(4)
    global_load_lds_dwordx4 v1, s[50:51] nt
    s_add_u32 s50, s50, 2048
    s_addc_u32 s51, s51, 0
    s_add_u32 m0, s5, 23552
    s_waitcnt vmcnt(4)
    global_load_lds_dwordx4 v2, s[50:51] nt
    s_add_u32 s50, s50, 26624
    s_addc_u32 s51, s51, 0
    s_add_u32 m0, s5, 24576
    s_waitcnt vmcnt(4)
    global_load_lds_dwordx4 v1, s[50:51] nt
    s_add_u32 s50, s50, 2048
    s_addc_u32 s51, s51, 0
    s_add_u32 m0, s5, 25600
    s_waitcnt vmcnt(4)
    global_load_lds_dwordx4 v2, s[50:51] nt
    s_add_u32 s50, s50, 2048
    s_addc_u32 s51, s51, 0
    s_add_u32 m0, s5, 26624
    s_waitcnt vmcnt(4)
    global_load_lds_dwordx4 v1, s[50:51] nt
    s_add_u32 s50, s50, 2048
    s_addc_u32 s51, s51, 0
    s_add_u32 m0, s5, 27648
    s_waitcnt vmcnt(4)
    global_load_lds_dwordx4 v2, s[50:51] nt
    s_add_u32 s50, s50, 26624
    s_addc_u32 s51, s51, 0
    s_add_u32 m0, s5, 28672
    s_waitcnt vmcnt(4)
    global_load_lds_dwordx4 v1, s[50:51] nt
    s_add_u32 s50, s50, 2048
    s_addc_u32 s51, s51, 0
    s_add_u32 m0, s5, 29696
    s_waitcnt vmcnt(4)
    global_load_lds_dwordx4 v2, s[50:51] nt
    s_add_u32 s50, s50, 2048
    s_addc_u32 s51, s51, 0
    s_add_u32 m0, s5, 30720
    s_waitcnt vmcnt(4)
    global_load_lds_dwordx4 v1, s[50:51] nt
    s_add_u32 s50, s50, 2048
    s_addc_u32 s51, s51, 0
    s_add_u32 m0, s5, 31744
    s_waitcnt vmcnt(4)
    global_load_lds_dwordx4 v2, s[50:51] nt
    s_waitcnt vmcnt(0)
    v_mov_b32 v1, 11072
    v_mov_b32 v2, 1
    s_waitcnt lgkmcnt(0)
    s_mov_b64 exec, 1
    ds_add_u32 v1, v2
    s_mov_b64 exec, -1
    v_mov_b32 v1, 11072
L_lw_41:
    ds_read_b32 v2, v1
    s_waitcnt lgkmcnt(0)
    v_cmp_gt_u32 vcc, 4, v2
    s_cbranch_vccnz L_lw_41
    v_lshrrev_b32 v1, 4, v0
    v_bfe_u32 v2, v0, 2, 2
    v_lshl_add_u32 v3, v1, 3, v2
    v_lshlrev_b32 v8, 7, v3
    v_lshrrev_b32 v2, 1, v2
    v_and_b32 v3, 1, v1
    v_lshl_add_u32 v2, v3, 1, v2
    v_xor_b32 v2, s70, v2
    v_lshl_add_u32 v8, v2, 5, v8
    v_and_b32 v2, 3, v0
    v_lshl_add_u32 v8, v2, 3, v8
    v_add_u32 v8, 16384, v8
    v_and_b32 v2, 1, v0
    v_mul_u32_u24 v2, 1088, v2
    v_lshl_add_u32 v9, v1, 4, v2
    v_add_u32 v9, 0, v9
    ds_read_b64_tr_b16 v[128:129], v8 offset:0
    ds_read_b64_tr_b16 v[130:131], v8 offset:512
    ds_read_b64_tr_b16 v[132:133], v8 offset:4096
    ds_read_b64_tr_b16 v[134:135], v8 offset:4608
    ds_read_b64_tr_b16 v[136:137], v8 offset:8192
    ds_read_b64_tr_b16 v[138:139], v8 offset:8704
    ds_read_b64_tr_b16 v[140:141], v8 offset:12288
    ds_read_b64_tr_b16 v[142:143], v8 offset:12800
    ds_read_b64_tr_b16 v[144:145], v8 offset:16384
    ds_read_b64_tr_b16 v[146:147], v8 offset:16896
    ds_read_b64_tr_b16 v[148:149], v8 offset:20480
    ds_read_b64_tr_b16 v[150:151], v8 offset:20992
    ds_read_b64_tr_b16 v[152:153], v8 offset:24576
    ds_read_b64_tr_b16 v[154:155], v8 offset:25088
    ds_read_b64_tr_b16 v[156:157], v8 offset:28672
    ds_read_b64_tr_b16 v[158:159], v8 offset:29184
    ds_read_b64_tr_b16 v[160:161], v8 offset:32768
    ds_read_b64_tr_b16 v[162:163], v8 offset:33280
    ds_read_b64_tr_b16 v[164:165], v8 offset:36864
    ds_read_b64_tr_b16 v[166:167], v8 offset:37376
    ds_read_b64_tr_b16 v[168:169], v8 offset:40960
    ds_read_b64_tr_b16 v[170:171], v8 offset:41472
    ds_read_b64_tr_b16 v[172:173], v8 offset:45056
    ds_read_b64_tr_b16 v[174:175], v8 offset:45568
    ds_read_b64_tr_b16 v[176:177], v8 offset:49152
    ds_read_b64_tr_b16 v[178:179], v8 offset:49664
    ds_read_b64_tr_b16 v[180:181], v8 offset:53248
    ds_read_b64_tr_b16 v[182:183], v8 offset:53760
    ds_read_b64_tr_b16 v[184:185], v8 offset:57344
    ds_read_b64_tr_b16 v[186:187], v8 offset:57856
    ds_read_b64_tr_b16 v[188:189], v8 offset:61440
    ds_read_b64_tr_b16 v[190:191], v8 offset:61952
    v_and_b32 v1, 1, v0
    v_lshlrev_b32 v1, 6, v1
    v_lshrrev_b32 v2, 4, v0
    v_lshl_add_u32 v1, v2, 4, v1
    s_lshl_b32 s4, s48, 9
    s_lshl_b32 s5, s70, 7
    s_add_u32 s4, s4, s5
    s_add_u32 s4, s4, 73728
    v_add_u32 v10, s4, v1
    s_lshr_b32 s4, s48, 3
    s_lshl_b32 s4, s4, 2
    s_add_u32 s4, s4, s70
    s_lshl_b32 s4, s4, 12
    s_add_u32 s4, s4, 335872
    v_lshrrev_b32 v3, 5, v0
    v_lshl_add_u32 v2, v3, 17, s4
    v_and_b32 v1, 31, v0
    v_lshl_add_u32 v84, v1, 4, v2
    v_mul_u32_u24 v3, 1088, v3
    s_lshl_b32 s4, s70, 8
    v_lshlrev_b32 v1, 3, v1
    v_add3_u32 v86, v1, v3, s4
    v_and_b32 v1, 3, v0
    v_lshl_add_u32 v85, v1, 10, v2
    s_waitcnt lgkmcnt(0)
    s_barrier
    s_mov_b32 s52, 262144
L_spin_42:
    global_load_dwordx2 v[80:81], v85, s[34:35] offset:512 sc1
    global_load_dwordx4 v[64:67], v84, s[34:35] offset:0 sc1
    global_load_dwordx4 v[68:71], v84, s[34:35] offset:1024 sc1
    global_load_dwordx4 v[72:75], v84, s[34:35] offset:2048 sc1
    global_load_dwordx4 v[76:79], v84, s[34:35] offset:3072 sc1
    s_waitcnt vmcnt(0)
    v_max3_u32 v82, v64, v65, v66
    v_max3_u32 v82, v82, v67, v68
    v_max3_u32 v82, v82, v69, v70
    v_max3_u32 v82, v82, v71, v72
    v_max3_u32 v82, v82, v73, v74
    v_max3_u32 v82, v82, v75, v76
    v_max3_u32 v82, v82, v77, v78
    v_max3_u32 v82, v82, v79, v80
    v_max_u32 v82, v82, v81
    v_cmp_eq_u32 vcc, -1, v82
    s_cbranch_vccz L_spindone_43
    s_sub_u32 s52, s52, 1
    s_cmp_lg_u32 s52, 0
    s_cbranch_scc1 L_spin_42
L_spindone_43:
    v_max_f32_dpp v82, v80, v80 quad_perm:[1,0,3,2] row_mask:0xf bank_mask:0xf
    s_nop 1
    v_max_f32_dpp v82, v82, v82 quad_perm:[2,3,0,1] row_mask:0xf bank_mask:0xf
    v_sub_f32 v80, v80, v82
    v_exp_f32 v80, v80
    s_nop 0
    v_mul_f32 v81, v81, v80
    s_nop 1
    v_add_f32_dpp v81, v81, v81 quad_perm:[1,0,3,2] row_mask:0xf bank_mask:0xf
    s_nop 1
    v_add_f32_dpp v81, v81, v81 quad_perm:[2,3,0,1] row_mask:0xf bank_mask:0xf
    v_rcp_f32 v81, v81
    s_nop 0
    v_mul_f32 v80, v80, v81
    s_nop 1
    v_mul_f32_dpp v88, v80, v64 quad_perm:[0,0,0,0] row_mask:0xf bank_mask:0xf
    v_mul_f32_dpp v89, v80, v65 quad_perm:[0,0,0,0] row_mask:0xf bank_mask:0xf
    v_mul_f32_dpp v90, v80, v66 quad_perm:[0,0,0,0] row_mask:0xf bank_mask:0xf
    v_mul_f32_dpp v91, v80, v67 quad_perm:[0,0,0,0] row_mask:0xf bank_mask:0xf
    v_fmac_f32_dpp v88, v80, v68 quad_perm:[1,1,1,1] row_mask:0xf bank_mask:0xf
    v_fmac_f32_dpp v89, v80, v69 quad_perm:[1,1,1,1] row_mask:0xf bank_mask:0xf
    v_fmac_f32_dpp v90, v80, v70 quad_perm:[1,1,1,1] row_mask:0xf bank_mask:0xf
    v_fmac_f32_dpp v91, v80, v71 quad_perm:[1,1,1,1] row_mask:0xf bank_mask:0xf
    v_fmac_f32_dpp v88, v80, v72 quad_perm:[2,2,2,2] row_mask:0xf bank_mask:0xf
    v_fmac_f32_dpp v89, v80, v73 quad_perm:[2,2,2,2] row_mask:0xf bank_mask:0xf
    v_fmac_f32_dpp v90, v80, v74 quad_perm:[2,2,2,2] row_mask:0xf bank_mask:0xf
    v_fmac_f32_dpp v91, v80, v75 quad_perm:[2,2,2,2] row_mask:0xf bank_mask:0xf
    v_fmac_f32_dpp v88, v80, v76 quad_perm:[3,3,3,3] row_mask:0xf bank_mask:0xf
    v_fmac_f32_dpp v89, v80, v77 quad_perm:[3,3,3,3] row_mask:0xf bank_mask:0xf
    v_fmac_f32_dpp v90, v80, v78 quad_perm:[3,3,3,3] row_mask:0xf bank_mask:0xf
    v_fmac_f32_dpp v91, v80, v79 quad_perm:[3,3,3,3] row_mask:0xf bank_mask:0xf
    v_cvt_pk_bf16_f32 v88, v88, v89
    v_cvt_pk_bf16_f32 v89, v90, v91
    ds_write_b64 v86, v[88:89] offset:0
    s_waitcnt lgkmcnt(0)
    s_barrier
    ds_read_b128 v[192:195], v9 offset:0
    ds_read_b128 v[196:199], v9 offset:64
    ds_read_b128 v[200:203], v9 offset:128
    ds_read_b128 v[204:207], v9 offset:192
    ds_read_b128 v[208:211], v9 offset:256
    ds_read_b128 v[212:215], v9 offset:320
    ds_read_b128 v[216:219], v9 offset:384
    ds_read_b128 v[220:223], v9 offset:448
    ds_read_b128 v[224:227], v9 offset:512
    ds_read_b128 v[228:231], v9 offset:576
    ds_read_b128 v[232:235], v9 offset:640
    ds_read_b128 v[236:239], v9 offset:704
    ds_read_b128 v[240:243], v9 offset:768
    ds_read_b128 v[244:247], v9 offset:832
    ds_read_b128 v[248:251], v9 offset:896
    ds_read_b128 v[252:255], v9 offset:960
    s_waitcnt lgkmcnt(12)
    v_mfma_f32_16x16x32_bf16 v[16:19], v[128:131], v[192:195], 0
    v_mfma_f32_16x16x32_bf16 v[16:19], v[132:135], v[196:199], v[16:19]
    v_mfma_f32_16x16x32_bf16 v[16:19], v[136:139], v[200:203], v[16:19]
    v_mfma_f32_16x16x32_bf16 v[16:19], v[140:143], v[204:207], v[16:19]
    s_waitcnt lgkmcnt(8)
    v_mfma_f32_16x16x32_bf16 v[16:19], v[144:147], v[208:211], v[16:19]
    v_mfma_f32_16x16x32_bf16 v[16:19], v[148:151], v[212:215], v[16:19]
    v_mfma_f32_16x16x32_bf16 v[16:19], v[152:155], v[216:219], v[16:19]
    v_mfma_f32_16x16x32_bf16 v[16:19], v[156:159], v[220:223], v[16:19]
    s_waitcnt lgkmcnt(4)
    v_mfma_f32_16x16x32_bf16 v[16:19], v[160:163], v[224:227], v[16:19]
    v_mfma_f32_16x16x32_bf16 v[16:19], v[164:167], v[228:231], v[16:19]
    v_mfma_f32_16x16x32_bf16 v[16:19], v[168:171], v[232:235], v[16:19]
    v_mfma_f32_16x16x32_bf16 v[16:19], v[172:175], v[236:239], v[16:19]
    s_waitcnt lgkmcnt(0)
    v_mfma_f32_16x16x32_bf16 v[16:19], v[176:179], v[240:243], v[16:19]
    v_mfma_f32_16x16x32_bf16 v[16:19], v[180:183], v[244:247], v[16:19]
    v_mfma_f32_16x16x32_bf16 v[16:19], v[184:187], v[248:251], v[16:19]
    v_mfma_f32_16x16x32_bf16 v[16:19], v[188:191], v[252:255], v[16:19]
    s_nop 7
    v_min_u32 v16, -2, v16
    v_min_u32 v17, -2, v17
    v_min_u32 v18, -2, v18
    v_min_u32 v19, -2, v19
    s_mov_b32 exec_lo, 0x00030003
    s_mov_b32 exec_hi, 0x00030003
    global_store_dwordx4 v10, v[16:19], s[98:99] sc1
    s_mov_b64 exec, -1
    s_branch L_fin
L_M0_go:
    v_lshrrev_b32 v3, 2, v0
    v_mul_u32_u24 v1, 3584, v3
    v_lshrrev_b32 v3, 2, v3
    v_and_b32 v3, 2, v3
    v_and_b32 v2, 3, v0
    v_xor_b32 v2, v2, v3
    v_lshlrev_b32 v2, 4, v2
    v_add_u32 v1, v1, v2
    s_mul_i32 s4, s70, 458752
    s_lshl_b32 s6, s48, 6
    s_add_u32 s4, s4, s6
    s_lshl_b32 s5, s70, 13
    s_add_u32 s50, s20, s4
    s_addc_u32 s51, s21, 0
    s_add_u32 m0, s5, 16384
    s_nop 0
    global_load_lds_dwordx4 v1, s[50:51]
    s_add_u32 s50, s50, 57344
    s_addc_u32 s51, s51, 0
    s_add_u32 m0, s5, 17408
    s_nop 0
    global_load_lds_dwordx4 v1, s[50:51]
    s_add_u32 s50, s50, 57344
    s_addc_u32 s51, s51, 0
    s_add_u32 m0, s5, 18432
    s_nop 0
    global_load_lds_dwordx4 v1, s[50:51]
    s_add_u32 s50, s50, 57344
    s_addc_u32 s51, s51, 0
    s_add_u32 m0, s5, 19456
    s_nop 0
    global_load_lds_dwordx4 v1, s[50:51]
    s_add_u32 s50, s50, 57344
    s_addc_u32 s51, s51, 0
    s_add_u32 m0, s5, 20480
    s_nop 0
    global_load_lds_dwordx4 v1, s[50:51]
    s_add_u32 s50, s50, 57344
    s_addc_u32 s51, s51, 0
    s_add_u32 m0, s5, 21504
    s_waitcnt vmcnt(4)
    global_load_lds_dwordx4 v1, s[50:51]
    s_add_u32 s50, s50, 57344
    s_addc_u32 s51, s51, 0
    s_add_u32 m0, s5, 22528
    s_waitcnt vmcnt(4)
    global_load_lds_dwordx4 v1, s[50:51]
    s_add_u32 s50, s50, 57344
    s_addc_u32 s51, s51, 0
    s_add_u32 m0, s5, 23552
    s_waitcnt vmcnt(4)
    global_load_lds_dwordx4 v1, s[50:51]
    s_add_u32 s50, s22, s4
    s_addc_u32 s51, s23, 0
    s_add_u32 m0, s5, 49152
    s_waitcnt vmcnt(4)
    global_load_lds_dwordx4 v1, s[50:51]
    s_add_u32 s50, s50, 57344
    s_addc_u32 s51, s51, 0
    s_add_u32 m0, s5, 50176
    s_waitcnt vmcnt(4)
    global_load_lds_dwordx4 v1, s[50:51]
    s_add_u32 s50, s50, 57344
    s_addc_u32 s51, s51, 0
    s_add_u32 m0, s5, 51200
    s_waitcnt vmcnt(4)
    global_load_lds_dwordx4 v1, s[50:51]
    s_add_u32 s50, s50, 57344
    s_addc_u32 s51, s51, 0
    s_add_u32 m0, s5, 52224
    s_waitcnt vmcnt(4)
    global_load_lds_dwordx4 v1, s[50:51]
    s_add_u32 s50, s50, 57344
    s_addc_u32 s51, s51, 0
    s_add_u32 m0, s5, 53248
    s_waitcnt vmcnt(4)
    global_load_lds_dwordx4 v1, s[50:51]
    s_add_u32 s50, s50, 57344
    s_addc_u32 s51, s51, 0
    s_add_u32 m0, s5, 54272
    s_waitcnt vmcnt(4)
    global_load_lds_dwordx4 v1, s[50:51]
    s_add_u32 s50, s50, 57344
    s_addc_u32 s51, s51, 0
    s_add_u32 m0, s5, 55296
    s_waitcnt vmcnt(4)
    global_load_lds_dwordx4 v1, s[50:51]
    s_add_u32 s50, s50, 57344
    s_addc_u32 s51, s51, 0
    s_add_u32 m0, s5, 56320
    s_waitcnt vmcnt(4)
    global_load_lds_dwordx4 v1, s[50:51]
    s_lshl_b32 s4, s48, 15
    s_add_u32 s4, s4, s5
    s_add_u32 s50, s24, s4
    s_addc_u32 s51, s25, 0
    s_and_b32 s6, s70, 1
    s_lshl_b32 s6, s6, 7
    v_lshlrev_b32 v3, 4, v0
    v_xor_b32 v3, s6, v3
    v_xor_b32 v2, 0, v3
    s_add_u32 m0, s5, 81920
    s_waitcnt vmcnt(4)
    global_load_lds_dwordx4 v2, s[50:51] nt
    s_add_u32 s50, s50, 1024
    s_addc_u32 s51, s51, 0
    v_xor_b32 v2, 32, v3
    s_add_u32 m0, s5, 82944
    s_waitcnt vmcnt(4)
    global_load_lds_dwordx4 v2, s[50:51] nt
    s_add_u32 s50, s50, 1024
    s_addc_u32 s51, s51, 0
    v_xor_b32 v2, 64, v3
    s_add_u32 m0, s5, 83968
    s_waitcnt vmcnt(4)
    global_load_lds_dwordx4 v2, s[50:51] nt
    s_add_u32 s50, s50, 1024
    s_addc_u32 s51, s51, 0
    v_xor_b32 v2, 96, v3
    s_add_u32 m0, s5, 84992
    s_waitcnt vmcnt(4)
    global_load_lds_dwordx4 v2, s[50:51] nt
    s_add_u32 s50, s50, 1024
    s_addc_u32 s51, s51, 0
    v_xor_b32 v2, 0, v3
    s_add_u32 m0, s5, 86016
    s_waitcnt vmcnt(4)
    global_load_lds_dwordx4 v2, s[50:51] nt
    s_add_u32 s50, s50, 1024
    s_addc_u32 s51, s51, 0
    v_xor_b32 v2, 32, v3
    s_add_u32 m0, s5, 87040
    s_waitcnt vmcnt(4)
    global_load_lds_dwordx4 v2, s[50:51] nt
    s_add_u32 s50, s50, 1024
    s_addc_u32 s51, s51, 0
    v_xor_b32 v2, 64, v3
    s_add_u32 m0, s5, 88064
    s_waitcnt vmcnt(4)
    global_load_lds_dwordx4 v2, s[50:51] nt
    s_add_u32 s50, s50, 1024
    s_addc_u32 s51, s51, 0
    v_xor_b32 v2, 96, v3
    s_add_u32 m0, s5, 89088
    s_waitcnt vmcnt(4)
    global_load_lds_dwordx4 v2, s[50:51] nt
    s_waitcnt vmcnt(0)
    v_mov_b32 v1, 11072
    v_mov_b32 v2, 1
    s_waitcnt lgkmcnt(0)
    s_mov_b64 exec, 1
    ds_add_u32 v1, v2
    s_mov_b64 exec, -1
    v_mov_b32 v1, 11072
L_lw_44:
    ds_read_b32 v2, v1
    s_waitcnt lgkmcnt(0)
    v_cmp_gt_u32 vcc, 4, v2
    s_cbranch_vccnz L_lw_44
    v_lshrrev_b32 v1, 4, v0
    v_bfe_u32 v2, v0, 2, 2
    v_lshl_add_u32 v3, v1, 3, v2
    v_lshlrev_b32 v3, 10, v3
    v_and_b32 v1, 1, v1
    v_lshl_add_u32 v1, v1, 2, v2
    v_and_b32 v2, 3, v0
    v_lshl_add_u32 v3, v2, 3, v3
    s_lshl_b32 s4, s70, 8
    s_add_u32 s4, s4, 81920
    v_add_u32 v3, s4, v3
    v_xor_b32 v2, 0, v1
    v_lshl_add_u32 v2, v2, 5, v3
    ds_read_b64_tr_b16 v[20:21], v2
    ds_read_b64_tr_b16 v[22:23], v2 offset:4096
    v_xor_b32 v2, 1, v1
    v_lshl_add_u32 v2, v2, 5, v3
    ds_read_b64_tr_b16 v[24:25], v2
    ds_read_b64_tr_b16 v[26:27], v2 offset:4096
    v_xor_b32 v2, 2, v1
    v_lshl_add_u32 v2, v2, 5, v3
    ds_read_b64_tr_b16 v[28:29], v2
    ds_read_b64_tr_b16 v[30:31], v2 offset:4096
    v_xor_b32 v2, 3, v1
    v_lshl_add_u32 v2, v2, 5, v3
    ds_read_b64_tr_b16 v[32:33], v2
    ds_read_b64_tr_b16 v[34:35], v2 offset:4096
    v_xor_b32 v2, 4, v1
    v_lshl_add_u32 v2, v2, 5, v3
    ds_read_b64_tr_b16 v[36:37], v2
    ds_read_b64_tr_b16 v[38:39], v2 offset:4096
    v_xor_b32 v2, 5, v1
    v_lshl_add_u32 v2, v2, 5, v3
    ds_read_b64_tr_b16 v[40:41], v2
    ds_read_b64_tr_b16 v[42:43], v2 offset:4096
    v_xor_b32 v2, 6, v1
    v_lshl_add_u32 v2, v2, 5, v3
    ds_read_b64_tr_b16 v[44:45], v2
    ds_read_b64_tr_b16 v[46:47], v2 offset:4096
    v_xor_b32 v2, 7, v1
    v_lshl_add_u32 v2, v2, 5, v3
    ds_read_b64_tr_b16 v[48:49], v2
    ds_read_b64_tr_b16 v[50:51], v2 offset:4096
    v_lshrrev_b32 v1, 4, v0
    v_bfe_u32 v2, v0, 2, 2
    v_lshl_add_u32 v3, v1, 3, v2
    v_lshlrev_b32 v8, 6, v3
    s_and_b32 s4, s70, 1
    s_lshr_b32 s5, s70, 1
    s_lshl_b32 s5, s5, 15
    v_and_b32 v2, 1, v1
    v_xor_b32 v2, s4, v2
    v_add_u32 v8, s5, v8
    v_lshl_add_u32 v8, v2, 5, v8
    v_and_b32 v2, 3, v0
    v_lshl_add_u32 v8, v2, 3, v8
    v_add_u32 v8, 16384, v8
    v_and_b32 v2, 1, v0
    v_mul_u32_u24 v2, 1088, v2
    v_lshl_add_u32 v9, v1, 4, v2
    v_add_u32 v9, 0, v9
    ds_read_b64_tr_b16 v[128:129], v8 offset:0
    ds_read_b64_tr_b16 v[130:131], v8 offset:256
    ds_read_b64_tr_b16 v[132:133], v8 offset:2048
    ds_read_b64_tr_b16 v[134:135], v8 offset:2304
    ds_read_b64_tr_b16 v[136:137], v8 offset:4096
    ds_read_b64_tr_b16 v[138:139], v8 offset:4352
    ds_read_b64_tr_b16 v[140:141], v8 offset:6144
    ds_read_b64_tr_b16 v[142:143], v8 offset:6400
    ds_read_b64_tr_b16 v[144:145], v8 offset:8192
    ds_read_b64_tr_b16 v[146:147], v8 offset:8448
    ds_read_b64_tr_b16 v[148:149], v8 offset:10240
    ds_read_b64_tr_b16 v[150:151], v8 offset:10496
    ds_read_b64_tr_b16 v[152:153], v8 offset:12288
    ds_read_b64_tr_b16 v[154:155], v8 offset:12544
    ds_read_b64_tr_b16 v[156:157], v8 offset:14336
    ds_read_b64_tr_b16 v[158:159], v8 offset:14592
    ds_read_b64_tr_b16 v[160:161], v8 offset:16384
    ds_read_b64_tr_b16 v[162:163], v8 offset:16640
    ds_read_b64_tr_b16 v[164:165], v8 offset:18432
    ds_read_b64_tr_b16 v[166:167], v8 offset:18688
    ds_read_b64_tr_b16 v[168:169], v8 offset:20480
    ds_read_b64_tr_b16 v[170:171], v8 offset:20736
    ds_read_b64_tr_b16 v[172:173], v8 offset:22528
    ds_read_b64_tr_b16 v[174:175], v8 offset:22784
    ds_read_b64_tr_b16 v[176:177], v8 offset:24576
    ds_read_b64_tr_b16 v[178:179], v8 offset:24832
    ds_read_b64_tr_b16 v[180:181], v8 offset:26624
    ds_read_b64_tr_b16 v[182:183], v8 offset:26880
    ds_read_b64_tr_b16 v[184:185], v8 offset:28672
    ds_read_b64_tr_b16 v[186:187], v8 offset:28928
    ds_read_b64_tr_b16 v[188:189], v8 offset:30720
    ds_read_b64_tr_b16 v[190:191], v8 offset:30976
    v_and_b32 v1, 1, v0
    v_lshlrev_b32 v1, 6, v1
    v_lshrrev_b32 v2, 4, v0
    v_lshl_add_u32 v12, v2, 4, v1
    v_lshl_add_u32 v1, v2, 3, v1
    s_lshr_b32 s4, s70, 1
    s_lshl_b32 s4, s4, 7
    s_and_b32 s5, s70, 1
    s_lshl_b32 s5, s5, 5
    s_add_u32 s4, s4, s5
    v_add_u32 v11, s4, v1
    v_and_b32 v1, 1, v0
    v_lshlrev_b32 v1, 6, v1
    v_lshrrev_b32 v2, 4, v0
    v_lshl_add_u32 v1, v2, 4, v1
    v_bfe_u32 v2, v0, 2, 2
    v_lshl_add_u32 v1, v2, 7, v1
    v_mov_b32 v4, 0
    v_mov_b32 v5, 0
    v_mov_b32 v6, 0
    v_mov_b32 v7, 0
    v_mov_b32 v52, 0
    v_mov_b32 v53, 0
    v_mov_b32 v54, 0
    v_mov_b32 v55, 0
    v_mov_b32 v120, 0
    v_mov_b32 v121, 0
    v_mov_b32 v122, 0
    v_mov_b32 v123, 0
    v_mov_b32 v124, 0
    v_mov_b32 v125, 0
    v_mov_b32 v126, 0
    v_mov_b32 v127, 0
    s_lshl_b32 s4, s48, 12
    s_lshl_b32 s5, s70, 10
    s_add_u32 s4, s4, s5
    s_add_u32 s4, s4, 106496
    v_add_u32 v10, s4, v1
    s_cmp_ge_u32 s70, 2
    s_cbranch_scc1 L_M1b
    s_lshl_b32 s4, s70, 10
    v_lshl_add_u32 v13, v0, 3, s4
    global_load_dwordx2 v[64:65], v13, s[8:9]
    global_load_dwordx2 v[66:67], v13, s[8:9] offset:512
    s_mul_i32 s4, s70, 1088
    v_lshl_add_u32 v14, v0, 3, s4
    v_lshrrev_b32 v1, 2, v0
    v_lshlrev_b32 v1, 6, v1
    v_and_b32 v2, 3, v0
    v_lshl_add_u32 v1, v2, 3, v1
    s_lshl_b32 s4, s70, 5
    s_add_u32 s4, s4, 67584
    v_add_u32 v3, s4, v1
    s_bfe_u32 s4, s48, 0x10004
    s_lshl_b32 s4, s4, 5
    s_and_b32 s5, s48, 15
    s_lshl_b32 s5, s5, 7
    s_add_u32 s4, s4, s5
    s_add_u32 s4, s4, 71680
    v_bfe_u32 v1, v0, 2, 1
    v_lshlrev_b32 v1, 6, v1
    v_lshl_add_u32 v1, v2, 3, v1
    v_add_u32 v82, s4, v1
    s_mov_b32 s52, 262144
L_spin_45:
    global_load_dwordx2 v[68:69], v3, s[34:35] offset:-2048 sc1
    global_load_dwordx2 v[70:71], v3, s[34:35] offset:-1024 sc1
    global_load_dwordx2 v[72:73], v3, s[34:35] offset:0 sc1
    global_load_dwordx2 v[74:75], v3, s[34:35] offset:1024 sc1
    global_load_dwordx2 v[76:77], v3, s[34:35] offset:2048 sc1
    global_load_dwordx2 v[78:79], v3, s[34:35] offset:3072 sc1
    global_load_dwordx2 v[80:81], v82, s[34:35] sc1
    s_waitcnt vmcnt(0)
    v_max3_u32 v83, v68, v69, v70
    v_max3_u32 v83, v83, v71, v72
    v_max3_u32 v83, v83, v73, v74
    v_max3_u32 v83, v83, v75, v76
    v_max3_u32 v83, v83, v77, v78
    v_max3_u32 v83, v83, v79, v80
    v_max_u32 v83, v83, v81
    v_cmp_eq_u32 vcc, -1, v83
    s_cbranch_vccz L_spindone_46
    s_sub_u32 s52, s52, 1
    s_cmp_lg_u32 s52, 0
    s_cbranch_scc1 L_spin_45
L_spindone_46:
    v_lshlrev_b32 v84, 16, v64
    v_and_b32 v85, s55, v64
    v_lshlrev_b32 v86, 16, v65
    v_and_b32 v87, s55, v65
    v_lshlrev_b32 v88, 16, v66
    v_and_b32 v89, s55, v66
    v_lshlrev_b32 v90, 16, v67
    v_and_b32 v91, s55, v67
    v_lshlrev_b32 v92, 16, v68
    v_and_b32 v93, s55, v68
    v_lshlrev_b32 v94, 16, v69
    v_and_b32 v95, s55, v69
    v_lshlrev_b32 v96, 16, v70
    v_and_b32 v97, s55, v70
    v_lshlrev_b32 v98, 16, v71
    v_and_b32 v99, s55, v71
    v_lshlrev_b32 v104, 16, v76
    v_and_b32 v105, s55, v76
    v_lshlrev_b32 v106, 16, v77
    v_and_b32 v107, s55, v77
    v_lshlrev_b32 v108, 16, v78
    v_and_b32 v109, s55, v78
    v_lshlrev_b32 v110, 16, v79
    v_and_b32 v111, s55, v79
    v_lshlrev_b32 v112, 16, v72
    v_and_b32 v113, s55, v72
    v_lshlrev_b32 v114, 16, v73
    v_and_b32 v115, s55, v73
    v_lshlrev_b32 v116, 16, v74
    v_and_b32 v117, s55, v74
    v_lshlrev_b32 v118, 16, v75
    v_and_b32 v119, s55, v75
    v_add_f32 v104, 1.0, v104
    v_add_f32 v105, 1.0, v105
    v_add_f32 v106, 1.0, v106
    v_add_f32 v107, 1.0, v107
    v_add_f32 v108, 1.0, v108
    v_add_f32 v109, 1.0, v109
    v_add_f32 v110, 1.0, v110
    v_add_f32 v111, 1.0, v111
    v_cvt_pk_bf16_f32 v100, v104, v105
    v_lshlrev_b32 v104, 16, v100
    v_and_b32 v105, s55, v100
    v_cvt_pk_bf16_f32 v101, v106, v107
    v_lshlrev_b32 v106, 16, v101
    v_and_b32 v107, s55, v101
    v_cvt_pk_bf16_f32 v100, v108, v109
    v_lshlrev_b32 v108, 16, v100
    v_and_b32 v109, s55, v100
    v_cvt_pk_bf16_f32 v101, v110, v111
    v_lshlrev_b32 v110, 16, v101
    v_and_b32 v111, s55, v101
    v_mov_b32 v15, 0x3b000000
    s_lshl_b32 s4, s70, 11
    v_lshl_add_u32 v13, v0, 4, s4
    v_lshrrev_b32 v1, 2, v0
    v_lshlrev_b32 v1, 7, v1
    v_and_b32 v2, 3, v0
    v_lshl_add_u32 v1, v2, 4, v1
    s_lshl_b32 s4, s70, 6
    s_add_u32 s4, s4, 73728
    v_add_u32 v56, s4, v1
    v_add_u32 v57, 4096, v56
    v_add_u32 v58, 8192, v56
    v_add_u32 v59, 12288, v56
    v_add_u32 v60, 16384, v56
    v_add_u32 v61, 20480, v56
    v_add_u32 v62, 24576, v56
    v_add_u32 v63, 28672, v56
    s_waitcnt lgkmcnt(0)
    s_barrier
    s_mov_b32 s52, 262144
L_spin_47:
    global_load_dwordx4 v[192:195], v56, s[34:35] sc1
    global_load_dwordx4 v[196:199], v56, s[34:35] offset:2048 sc1
    global_load_dwordx4 v[200:203], v57, s[34:35] sc1
    global_load_dwordx4 v[204:207], v57, s[34:35] offset:2048 sc1
    global_load_dwordx4 v[208:211], v58, s[34:35] sc1
    global_load_dwordx4 v[212:215], v58, s[34:35] offset:2048 sc1
    global_load_dwordx4 v[216:219], v59, s[34:35] sc1
    global_load_dwordx4 v[220:223], v59, s[34:35] offset:2048 sc1
    global_load_dwordx4 v[224:227], v60, s[34:35] sc1
    global_load_dwordx4 v[228:231], v60, s[34:35] offset:2048 sc1
    global_load_dwordx4 v[232:235], v61, s[34:35] sc1
    global_load_dwordx4 v[236:239], v61, s[34:35] offset:2048 sc1
    global_load_dwordx4 v[240:243], v62, s[34:35] sc1
    global_load_dwordx4 v[244:247], v62, s[34:35] offset:2048 sc1
    global_load_dwordx4 v[248:251], v63, s[34:35] sc1
    global_load_dwordx4 v[252:255], v63, s[34:35] offset:2048 sc1
    s_waitcnt vmcnt(0)
    v_max3_u32 v83, v192, v193, v194
    v_max3_u32 v83, v83, v195, v196
    v_max3_u32 v83, v83, v197, v198
    v_max3_u32 v83, v83, v199, v200
    v_max3_u32 v83, v83, v201, v202
    v_max3_u32 v83, v83, v203, v204
    v_max3_u32 v83, v83, v205, v206
    v_max3_u32 v83, v83, v207, v208
    v_max3_u32 v83, v83, v209, v210
    v_max3_u32 v83, v83, v211, v212
    v_max3_u32 v83, v83, v213, v214
    v_max3_u32 v83, v83, v215, v216
    v_max3_u32 v83, v83, v217, v218
    v_max3_u32 v83, v83, v219, v220
    v_max3_u32 v83, v83, v221, v222
    v_max3_u32 v83, v83, v223, v224
    v_max3_u32 v83, v83, v225, v226
    v_max3_u32 v83, v83, v227, v228
    v_max3_u32 v83, v83, v229, v230
    v_max3_u32 v83, v83, v231, v232
    v_max3_u32 v83, v83, v233, v234
    v_max3_u32 v83, v83, v235, v236
    v_max3_u32 v83, v83, v237, v238
    v_max3_u32 v83, v83, v239, v240
    v_max3_u32 v83, v83, v241, v242
    v_max3_u32 v83, v83, v243, v244
    v_max3_u32 v83, v83, v245, v246
    v_max3_u32 v83, v83, v247, v248
    v_max3_u32 v83, v83, v249, v250
    v_max3_u32 v83, v83, v251, v252
    v_max3_u32 v83, v83, v253, v254
    v_max_u32 v83, v83, v255
    v_cmp_eq_u32 vcc, -1, v83
    s_cbranch_vccz L_spindone_48
    s_sub_u32 s52, s52, 1
    s_cmp_lg_u32 s52, 0
    s_cbranch_scc1 L_spin_47
L_spindone_48:
    v_pk_add_f32 v[192:193], v[192:193], v[224:225]
    v_pk_add_f32 v[194:195], v[194:195], v[226:227]
    v_pk_add_f32 v[196:197], v[196:197], v[228:229]
    v_pk_add_f32 v[198:199], v[198:199], v[230:231]
    v_pk_add_f32 v[200:201], v[200:201], v[232:233]
    v_pk_add_f32 v[202:203], v[202:203], v[234:235]
    v_pk_add_f32 v[204:205], v[204:205], v[236:237]
    v_pk_add_f32 v[206:207], v[206:207], v[238:239]
    v_pk_add_f32 v[208:209], v[208:209], v[240:241]
    v_pk_add_f32 v[210:211], v[210:211], v[242:243]
    v_pk_add_f32 v[212:213], v[212:213], v[244:245]
    v_pk_add_f32 v[214:215], v[214:215], v[246:247]
    v_pk_add_f32 v[216:217], v[216:217], v[248:249]
    v_pk_add_f32 v[218:219], v[218:219], v[250:251]
    v_pk_add_f32 v[220:221], v[220:221], v[252:253]
    v_pk_add_f32 v[222:223], v[222:223], v[254:255]
    v_pk_add_f32 v[192:193], v[192:193], v[208:209]
    v_pk_add_f32 v[194:195], v[194:195], v[210:211]
    v_pk_add_f32 v[196:197], v[196:197], v[212:213]
    v_pk_add_f32 v[198:199], v[198:199], v[214:215]
    v_pk_add_f32 v[200:201], v[200:201], v[216:217]
    v_pk_add_f32 v[202:203], v[202:203], v[218:219]
    v_pk_add_f32 v[204:205], v[204:205], v[220:221]
    v_pk_add_f32 v[206:207], v[206:207], v[222:223]
    v_pk_add_f32 v[192:193], v[192:193], v[200:201]
    v_pk_add_f32 v[194:195], v[194:195], v[202:203]
    v_pk_add_f32 v[196:197], v[196:197], v[204:205]
    v_pk_add_f32 v[198:199], v[198:199], v[206:207]
    v_fmac_f32 v84, v92, v192
    v_fmac_f32 v85, v93, v193
    v_fmac_f32 v86, v94, v194
    v_fmac_f32 v87, v95, v195
    v_fmac_f32 v88, v96, v196
    v_fmac_f32 v89, v97, v197
    v_fmac_f32 v90, v98, v198
    v_fmac_f32 v91, v99, v199
    v_readfirstlane_b32 s71, v84
    ds_write_b128 v13, v[84:87] offset:6976
    ds_write_b128 v13, v[88:91] offset:8000
    v_subrev_f32 v92, s71, v84
    v_subrev_f32 v93, s71, v85
    v_subrev_f32 v94, s71, v86
    v_subrev_f32 v95, s71, v87
    v_subrev_f32 v96, s71, v88
    v_subrev_f32 v97, s71, v89
    v_subrev_f32 v98, s71, v90
    v_subrev_f32 v99, s71, v91
    v_pk_add_f32 v[100:101], v[92:93], v[94:95]
    v_pk_mul_f32 v[102:103], v[92:93], v[92:93]
    v_pk_add_f32 v[100:101], v[100:101], v[96:97]
    v_pk_fma_f32 v[102:103], v[94:95], v[94:95], v[102:103]
    v_pk_add_f32 v[100:101], v[100:101], v[98:99]
    v_pk_fma_f32 v[102:103], v[96:97], v[96:97], v[102:103]
    v_add_f32 v100, v100, v101
    v_pk_fma_f32 v[102:103], v[98:99], v[98:99], v[102:103]
    v_add_f32 v101, v102, v103
    v_add_f32_dpp v100, v100, v100 row_ror:8 row_mask:0xf bank_mask:0xf
    s_nop 0
    v_add_f32_dpp v101, v101, v101 row_ror:8 row_mask:0xf bank_mask:0xf
    v_add_f32_dpp v100, v100, v100 row_ror:4 row_mask:0xf bank_mask:0xf
    s_nop 0
    v_add_f32_dpp v101, v101, v101 row_ror:4 row_mask:0xf bank_mask:0xf
    v_add_f32_dpp v100, v100, v100 row_ror:2 row_mask:0xf bank_mask:0xf
    s_nop 0
    v_add_f32_dpp v101, v101, v101 row_ror:2 row_mask:0xf bank_mask:0xf
    v_add_f32_dpp v100, v100, v100 row_ror:1 row_mask:0xf bank_mask:0xf
    s_nop 0
    v_add_f32_dpp v101, v101, v101 row_ror:1 row_mask:0xf bank_mask:0xf
    v_add_f32_dpp v100, v100, v100 row_bcast:15 row_mask:0xa bank_mask:0xf
    s_nop 0
    v_add_f32_dpp v101, v101, v101 row_bcast:15 row_mask:0xa bank_mask:0xf
    v_add_f32_dpp v100, v100, v100 row_bcast:31 row_mask:0xc bank_mask:0xf
    s_nop 0
    v_add_f32_dpp v101, v101, v101 row_bcast:31 row_mask:0xc bank_mask:0xf
    v_readlane_b32 s67, v100, 63
    v_readlane_b32 s7, v101, 63
    s_nop 0
    v_mul_f32 v101, s67, v15
    v_mul_f32 v102, s7, v15
    v_fma_f32 v102, -v101, v101, v102
    v_max_f32 v102, 0, v102
    v_add_f32 v102, 0x3727c5ac, v102
    v_rsq_f32 v102, v102
    v_sub_f32 v92, v92, v101
    v_sub_f32 v93, v93, v101
    v_sub_f32 v94, v94, v101
    v_sub_f32 v95, v95, v101
    v_sub_f32 v96, v96, v101
    v_sub_f32 v97, v97, v101
    v_sub_f32 v98, v98, v101
    v_sub_f32 v99, v99, v101
    v_mul_f32 v104, v104, v102
    v_mul_f32 v105, v105, v102
    v_mul_f32 v106, v106, v102
    v_mul_f32 v107, v107, v102
    v_mul_f32 v108, v108, v102
    v_mul_f32 v109, v109, v102
    v_mul_f32 v110, v110, v102
    v_mul_f32 v111, v111, v102
    v_fmac_f32 v112, v92, v104
    v_fmac_f32 v113, v93, v105
    v_fmac_f32 v114, v94, v106
    v_fmac_f32 v115, v95, v107
    v_fmac_f32 v116, v96, v108
    v_fmac_f32 v117, v97, v109
    v_fmac_f32 v118, v98, v110
    v_fmac_f32 v119, v99, v111
    v_cvt_pk_bf16_f32 v68, v112, v113
    v_cvt_pk_bf16_f32 v69, v114, v115
    v_cvt_pk_bf16_f32 v70, v116, v117
    v_cvt_pk_bf16_f32 v71, v118, v119
    ds_write_b64 v14, v[68:69] offset:0
    ds_write_b64 v14, v[70:71] offset:512
    s_branch L_M1c
L_M1b:
    s_waitcnt lgkmcnt(0)
    s_barrier
L_M1c:
    s_waitcnt lgkmcnt(0)
    s_barrier
    ds_read_b128 v[192:195], v9 offset:0
    ds_read_b128 v[196:199], v9 offset:64
    ds_read_b128 v[200:203], v9 offset:128
    ds_read_b128 v[204:207], v9 offset:192
    ds_read_b128 v[208:211], v9 offset:256
    ds_read_b128 v[212:215], v9 offset:320
    ds_read_b128 v[216:219], v9 offset:384
    ds_read_b128 v[220:223], v9 offset:448
    ds_read_b128 v[224:227], v9 offset:512
    ds_read_b128 v[228:231], v9 offset:576
    ds_read_b128 v[232:235], v9 offset:640
    ds_read_b128 v[236:239], v9 offset:704
    ds_read_b128 v[240:243], v9 offset:768
    ds_read_b128 v[244:247], v9 offset:832
    ds_read_b128 v[248:251], v9 offset:896
    ds_read_b128 v[252:255], v9 offset:960
    s_waitcnt lgkmcnt(12)
    v_mfma_f32_16x16x32_bf16 v[16:19], v[128:131], v[192:195], 0
    v_mfma_f32_16x16x32_bf16 v[16:19], v[132:135], v[196:199], v[16:19]
    v_mfma_f32_16x16x32_bf16 v[16:19], v[136:139], v[200:203], v[16:19]
    v_mfma_f32_16x16x32_bf16 v[16:19], v[140:143], v[204:207], v[16:19]
    s_waitcnt lgkmcnt(8)
    v_mfma_f32_16x16x32_bf16 v[16:19], v[144:147], v[208:211], v[16:19]
    v_mfma_f32_16x16x32_bf16 v[16:19], v[148:151], v[212:215], v[16:19]
    v_mfma_f32_16x16x32_bf16 v[16:19], v[152:155], v[216:219], v[16:19]
    v_mfma_f32_16x16x32_bf16 v[16:19], v[156:159], v[220:223], v[16:19]
    s_waitcnt lgkmcnt(4)
    v_mfma_f32_16x16x32_bf16 v[16:19], v[160:163], v[224:227], v[16:19]
    v_mfma_f32_16x16x32_bf16 v[16:19], v[164:167], v[228:231], v[16:19]
    v_mfma_f32_16x16x32_bf16 v[16:19], v[168:171], v[232:235], v[16:19]
    v_mfma_f32_16x16x32_bf16 v[16:19], v[172:175], v[236:239], v[16:19]
    s_waitcnt lgkmcnt(0)
    v_mfma_f32_16x16x32_bf16 v[16:19], v[176:179], v[240:243], v[16:19]
    v_mfma_f32_16x16x32_bf16 v[16:19], v[180:183], v[244:247], v[16:19]
    v_mfma_f32_16x16x32_bf16 v[16:19], v[184:187], v[248:251], v[16:19]
    v_mfma_f32_16x16x32_bf16 v[16:19], v[188:191], v[252:255], v[16:19]
    s_nop 7
    v_cvt_pk_bf16_f32 v16, v16, v17
    v_cvt_pk_bf16_f32 v17, v18, v19
    s_mov_b32 exec_lo, 0x00030003
    s_mov_b32 exec_hi, 0x00030003
    ds_write_b64 v11, v[16:17] offset:6720
    s_mov_b64 exec, -1
    s_waitcnt lgkmcnt(0)
    s_barrier
    ds_read_b128 v[84:87], v12 offset:6720
    ds_read_b128 v[88:91], v12 offset:6848
    s_waitcnt lgkmcnt(1)
    v_lshlrev_b32 v92, 16, v84
    v_and_b32 v93, s55, v84
    v_lshlrev_b32 v94, 16, v85
    v_and_b32 v95, s55, v85
    v_lshlrev_b32 v96, 16, v86
    v_and_b32 v97, s55, v86
    v_lshlrev_b32 v98, 16, v87
    v_and_b32 v99, s55, v87
    s_waitcnt lgkmcnt(0)
    v_lshlrev_b32 v100, 16, v88
    v_and_b32 v101, s55, v88
    v_lshlrev_b32 v102, 16, v89
    v_and_b32 v103, s55, v89
    v_lshlrev_b32 v104, 16, v90
    v_and_b32 v105, s55, v90
    v_lshlrev_b32 v106, 16, v91
    v_and_b32 v107, s55, v91
    v_mul_f32 v92, v92, v100
    v_mul_f32 v93, v93, v101
    v_mul_f32 v94, v94, v102
    v_mul_f32 v95, v95, v103
    v_mul_f32 v96, v96, v104
    v_mul_f32 v97, v97, v105
    v_mul_f32 v98, v98, v106
    v_mul_f32 v99, v99, v107
    v_cvt_pk_bf16_f32 v84, v92, v93
    v_cvt_pk_bf16_f32 v85, v94, v95
    v_cvt_pk_bf16_f32 v86, v96, v97
    v_cvt_pk_bf16_f32 v87, v98, v99
    v_mov_b32_dpp v4, v84 quad_perm:[0,1,2,3] row_mask:0xf bank_mask:0x1
    v_mov_b32_dpp v5, v85 quad_perm:[0,1,2,3] row_mask:0xf bank_mask:0x1
    v_mov_b32_dpp v6, v86 quad_perm:[0,1,2,3] row_mask:0xf bank_mask:0x1
    v_mov_b32_dpp v7, v87 quad_perm:[0,1,2,3] row_mask:0xf bank_mask:0x1
    v_mov_b32_dpp v52, v84 quad_perm:[0,1,2,3] row_mask:0xf bank_mask:0x2
    v_mov_b32_dpp v53, v85 quad_perm:[0,1,2,3] row_mask:0xf bank_mask:0x2
    v_mov_b32_dpp v54, v86 quad_perm:[0,1,2,3] row_mask:0xf bank_mask:0x2
    v_mov_b32_dpp v55, v87 quad_perm:[0,1,2,3] row_mask:0xf bank_mask:0x2
    v_mov_b32_dpp v120, v84 quad_perm:[0,1,2,3] row_mask:0xf bank_mask:0x4
    v_mov_b32_dpp v121, v85 quad_perm:[0,1,2,3] row_mask:0xf bank_mask:0x4
    v_mov_b32_dpp v122, v86 quad_perm:[0,1,2,3] row_mask:0xf bank_mask:0x4
    v_mov_b32_dpp v123, v87 quad_perm:[0,1,2,3] row_mask:0xf bank_mask:0x4
    v_mov_b32_dpp v124, v84 quad_perm:[0,1,2,3] row_mask:0xf bank_mask:0x8
    v_mov_b32_dpp v125, v85 quad_perm:[0,1,2,3] row_mask:0xf bank_mask:0x8
    v_mov_b32_dpp v126, v86 quad_perm:[0,1,2,3] row_mask:0xf bank_mask:0x8
    v_mov_b32_dpp v127, v87 quad_perm:[0,1,2,3] row_mask:0xf bank_mask:0x8
    v_mfma_f32_16x16x32_bf16 v[128:131], v[20:23], v[4:7], 0
    v_mfma_f32_16x16x32_bf16 v[132:135], v[36:39], v[4:7], 0
    v_mfma_f32_16x16x32_bf16 v[128:131], v[24:27], v[52:55], v[128:131]
    v_mfma_f32_16x16x32_bf16 v[132:135], v[40:43], v[52:55], v[132:135]
    v_mfma_f32_16x16x32_bf16 v[128:131], v[28:31], v[120:123], v[128:131]
    v_mfma_f32_16x16x32_bf16 v[132:135], v[44:47], v[120:123], v[132:135]
    v_mfma_f32_16x16x32_bf16 v[128:131], v[32:35], v[124:127], v[128:131]
    v_mfma_f32_16x16x32_bf16 v[132:135], v[48:51], v[124:127], v[132:135]
    s_mov_b32 exec_lo, 0x33333333
    s_mov_b32 exec_hi, 0x33333333
    s_nop 4
    v_min_u32 v128, -2, v128
    v_min_u32 v129, -2, v129
    v_min_u32 v130, -2, v130
    v_min_u32 v131, -2, v131
    global_store_dwordx4 v10, v[128:131], s[98:99] offset:0 sc1
    v_min_u32 v132, -2, v132
    v_min_u32 v133, -2, v133
    v_min_u32 v134, -2, v134
    v_min_u32 v135, -2, v135
    global_store_dwordx4 v10, v[132:135], s[98:99] offset:512 sc1
    s_mov_b64 exec, -1
    s_cmp_lg_u32 s70, 0
    s_cbranch_scc1 L_Fend
    s_cmp_ge_u32 s48, 32
    s_cbranch_scc1 L_Fend
    s_mov_b32 s50, s30
    s_mov_b32 s51, s31
    s_lshr_b32 s4, s48, 4
    s_and_b32 s5, s48, 15
    s_lshl_b32 s6, s4, 6
    s_lshl_b32 s7, s5, 8
    s_add_u32 s6, s6, s7
    s_add_u32 s6, s6, 106496
    v_lshrrev_b32 v1, 3, v0
    v_lshlrev_b32 v1, 12, v1
    v_bfe_u32 v2, v0, 2, 1
    v_lshl_add_u32 v1, v2, 7, v1
    v_and_b32 v2, 3, v0
    v_lshl_add_u32 v1, v2, 4, v1
    v_add_u32 v56, s6, v1
    v_and_b32 v2, 7, v0
    v_add_u32 v57, 32768, v56
    v_add_u32 v58, 65536, v56
    v_add_u32 v59, 98304, v56
    v_add_u32 v60, 131072, v56
    v_add_u32 v61, 163840, v56
    v_add_u32 v62, 196608, v56
    s_lshl_b32 s6, s4, 10
    s_lshl_b32 s7, s5, 6
    s_add_u32 s6, s6, s7
    v_lshl_add_u32 v3, v2, 3, s6
    v_lshlrev_b32 v1, 1, v3
    ds_read_b128 v[236:239], v1 offset:6976
    v_lshlrev_b32 v232, 16, v80
    v_and_b32 v233, s55, v80
    v_lshlrev_b32 v234, 16, v81
    v_and_b32 v235, s55, v81
    s_mov_b32 s52, 262144
L_spin_49:
    global_load_dwordx4 v[192:195], v56, s[34:35] sc1
    global_load_dwordx4 v[196:199], v57, s[34:35] sc1
    global_load_dwordx4 v[200:203], v58, s[34:35] sc1
    global_load_dwordx4 v[204:207], v59, s[34:35] sc1
    global_load_dwordx4 v[208:211], v60, s[34:35] sc1
    global_load_dwordx4 v[212:215], v61, s[34:35] sc1
    global_load_dwordx4 v[216:219], v62, s[34:35] sc1
    s_waitcnt vmcnt(0)
    v_max3_u32 v83, v192, v193, v194
    v_max3_u32 v83, v83, v195, v196
    v_max3_u32 v83, v83, v197, v198
    v_max3_u32 v83, v83, v199, v200
    v_max3_u32 v83, v83, v201, v202
    v_max3_u32 v83, v83, v203, v204
    v_max3_u32 v83, v83, v205, v206
    v_max3_u32 v83, v83, v207, v208
    v_max3_u32 v83, v83, v209, v210
    v_max3_u32 v83, v83, v211, v212
    v_max3_u32 v83, v83, v213, v214
    v_max3_u32 v83, v83, v215, v216
    v_max3_u32 v83, v83, v217, v218
    v_max_u32 v83, v83, v219
    v_cmp_eq_u32 vcc, -1, v83
    s_cbranch_vccz L_spindone_50
    s_sub_u32 s52, s52, 1
    s_cmp_lg_u32 s52, 0
    s_cbranch_scc1 L_spin_49
L_spindone_50:
    v_pk_add_f32 v[192:193], v[192:193], v[196:197]
    v_pk_add_f32 v[194:195], v[194:195], v[198:199]
    v_pk_add_f32 v[200:201], v[200:201], v[204:205]
    v_pk_add_f32 v[202:203], v[202:203], v[206:207]
    v_pk_add_f32 v[208:209], v[208:209], v[212:213]
    v_pk_add_f32 v[210:211], v[210:211], v[214:215]
    v_pk_add_f32 v[192:193], v[192:193], v[200:201]
    v_pk_add_f32 v[194:195], v[194:195], v[202:203]
    v_pk_add_f32 v[208:209], v[208:209], v[216:217]
    v_pk_add_f32 v[210:211], v[210:211], v[218:219]
    v_pk_add_f32 v[192:193], v[192:193], v[208:209]
    v_pk_add_f32 v[194:195], v[194:195], v[210:211]
    s_nop 0
    v_add_f32_dpp v192, v192, v192 row_ror:8 row_mask:0xf bank_mask:0xf
    v_add_f32_dpp v193, v193, v193 row_ror:8 row_mask:0xf bank_mask:0xf
    v_add_f32_dpp v194, v194, v194 row_ror:8 row_mask:0xf bank_mask:0xf
    v_add_f32_dpp v195, v195, v195 row_ror:8 row_mask:0xf bank_mask:0xf
    v_mov_b32 v196, v192
    v_mov_b32 v197, v193
    v_mov_b32 v198, v194
    v_mov_b32 v199, v195
    v_permlane16_swap_b32 v192, v196
    v_permlane16_swap_b32 v193, v197
    v_permlane16_swap_b32 v194, v198
    v_permlane16_swap_b32 v195, v199
    v_add_f32 v192, v192, v196
    v_add_f32 v193, v193, v197
    v_add_f32 v194, v194, v198
    v_add_f32 v195, v195, v199
    v_mov_b32 v196, v192
    v_mov_b32 v197, v193
    v_mov_b32 v198, v194
    v_mov_b32 v199, v195
    v_permlane32_swap_b32 v192, v196
    v_permlane32_swap_b32 v193, v197
    v_permlane32_swap_b32 v194, v198
    v_permlane32_swap_b32 v195, v199
    v_add_f32 v192, v192, v196
    v_add_f32 v193, v193, v197
    v_add_f32 v194, v194, v198
    v_add_f32 v195, v195, v199
    s_waitcnt lgkmcnt(0)
    v_fma_f32 v192, v192, v232, v236
    v_fma_f32 v193, v193, v233, v237
    v_fma_f32 v194, v194, v234, v238
    v_fma_f32 v195, v195, v235, v239
    v_cvt_pk_bf16_f32 v192, v192, v193
    v_cvt_pk_bf16_f32 v193, v194, v195
    s_mov_b64 exec, 0xff
    global_store_dwordx2 v3, v[192:193], s[50:51]
    s_mov_b64 exec, -1
L_Fend:
L_hexit:
L_fin:
L_end:
    s_endpgm
.section .rodata,"a"
.p2align 6
.amdhsa_kernel adaLN_cond__mha_block_cached__glu_gated_bilinear__decode_kernel
  .amdhsa_next_free_vgpr 256
  .amdhsa_next_free_sgpr 102
  .amdhsa_accum_offset 256
  .amdhsa_group_segment_fixed_size 0
  .amdhsa_kernarg_size 112
  .amdhsa_user_sgpr_count 2
  .amdhsa_user_sgpr_kernarg_segment_ptr 1
  .amdhsa_system_sgpr_workgroup_id_x 1
  .amdhsa_float_denorm_mode_32 3
.end_amdhsa_kernel
```
